```python
import torch

def _softmax(x, axis=-1):
    return torch.softmax(x, dim=axis)
def _gelu(x):
    return torch.nn.functional.gelu(x, approximate="tanh")
def _silu(x):
    return torch.nn.functional.silu(x)
def _sigmoid(x):
    return torch.sigmoid(x)
def _layernorm(x, axis=-1, eps=1e-5):
    m = x.mean(dim=axis, keepdim=True)
    v = x.var(dim=axis, keepdim=True, unbiased=False)
    return (x - m) / torch.sqrt(v + eps)
def _scatter_add(tgt, idx, src, axis=0):
    return tgt.clone().index_add_(axis, idx, src)
def _segment_sum(src, seg, n):
    out = torch.zeros((n,) + src.shape[1:], dtype=src.dtype)
    return out.index_add_(0, seg, src)
def _pad(x, pw):
    flat = tuple(v for pair in reversed(pw) for v in pair)
    return torch.nn.functional.pad(x, flat)

kernel_name = 'recurrent_scan__ssm_conv_s4__mixer_channel_mlp__prompt'

def setup_inputs():

    _w = (lambda a: (lambda t: t.to(torch.bfloat16) if t.is_floating_point() else t)(torch.as_tensor(a)))
    def _A_setup():
        B, L, D, N = 1, 2048, 448, 256
        A_re = -(lambda _x: torch.exp(torch.as_tensor(_x)))((lambda *s: torch.randn(*s, dtype=torch.bfloat16) * 3.2)(D, N))
        A_im = torch.pi * (lambda *s: torch.randn(*s, dtype=torch.bfloat16) * 0.2)(D, N)
        B_re = (lambda *s: torch.randn(*s, dtype=torch.bfloat16) * 0.2)(D, N)
        B_im = (lambda *s: torch.randn(*s, dtype=torch.bfloat16) * 0.2)(D, N)
        C_re = (lambda *s: torch.randn(*s, dtype=torch.bfloat16) * 0.2)(D, N)
        C_im = (lambda *s: torch.randn(*s, dtype=torch.bfloat16) * 0.2)(D, N)
        log_dt = (lambda *s: torch.randn(*s, dtype=torch.bfloat16) * 0.2)(D) * 0.5 - 4.0
        Dskip = (lambda *s: torch.randn(*s, dtype=torch.bfloat16) * 0.2)(D)
        return {
            "u": _w((lambda *s: torch.randn(*s, dtype=torch.bfloat16) * 0.05)(B, L, D)),
            "A_re": _w(A_re),
            "A_im": _w(A_im),
            "B_re": _w(B_re),
            "B_im": _w(B_im),
            "C_re": _w(C_re),
            "C_im": _w(C_im),
            "log_dt": _w(log_dt),
            "Dskip": _w(Dskip),
        }
    _A_in = _A_setup()

    def _B_setup():
        B, S, D, F = 1, 2048, 448, 1792
        return {
            "x": _w((lambda *s: torch.randn(*s, dtype=torch.bfloat16) * 0.05)(B, S, D)),
            "w1": _w((lambda *s: torch.randn(*s, dtype=torch.bfloat16) * 3.2)(D, F) * (D ** -0.5)),
            "b1": _w((lambda *s: torch.randn(*s, dtype=torch.bfloat16) * 1.6)(F)),
            "w2": _w((lambda *s: torch.randn(*s, dtype=torch.bfloat16) * 0.1)(F, D) * (F ** -0.5)),
            "b2": _w((lambda *s: torch.randn(*s, dtype=torch.bfloat16) * 0.2)(D)),
        }
    _B_in = _B_setup()

    return {
        "A_u": _A_in["u"],
        "A_A_re": _A_in["A_re"],
        "A_A_im": _A_in["A_im"],
        "A_B_re": _A_in["B_re"],
        "A_B_im": _A_in["B_im"],
        "A_C_re": _A_in["C_re"],
        "A_C_im": _A_in["C_im"],
        "A_log_dt": _A_in["log_dt"],
        "A_Dskip": _A_in["Dskip"],
        "B_x": _B_in["x"],
        "B_w1": _B_in["w1"],
        "B_b1": _B_in["b1"],
        "B_w2": _B_in["w2"],
        "B_b2": _B_in["b2"],
    }

def reference(A_u, A_A_re, A_A_im, A_B_re, A_B_im, A_C_re, A_C_im, A_log_dt, A_Dskip, B_x, B_w1, B_b1, B_w2, B_b2):
    def _A_ref(u, A_re, A_im, B_re, B_im, C_re, C_im, log_dt, Dskip):
        Bsz, L, D = u.shape
        dt = torch.exp(log_dt)[:, None]
        A = A_re + 1j * A_im
        Bc = B_re + 1j * B_im
        Cc = C_re + 1j * C_im
        logdA = dt * A
        dB = dt * Bc
        l = (lambda x, dt: x.to(dt))(torch.arange(L), A_re.dtype)
        P = torch.exp(logdA[:, :, None] * l[None, None, :])
        K = torch.einsum("dn,dnl,dn->dl", Cc, P, dB).real
        L2 = 2 * L
        Kp = _pad(K, ((0, 0), (0, L)))
        up = (lambda x, *d: x.permute(*d))(u, 0, 2, 1)
        up = _pad(up, ((0, 0), (0, 0), (0, L)))
        Kf = (lambda x, axes=(-2,-1): torch.fft.rfft2(x.float(), dim=axes))(Kp[:, None, :], axes=(-2, -1))
        Uf = (lambda x, axes=(-2,-1): torch.fft.rfft2(x.float(), dim=axes))(up[:, :, None, :], axes=(-2, -1))
        Yf = Uf * Kf[None, :, :, :]
        y = (lambda x, s, axes=(-2,-1): torch.fft.irfft2(x, s=s, dim=axes).to(torch.bfloat16))(Yf, (1, L2), axes=(-2, -1))[:, :, 0, :L]
        y = (lambda x, *d: x.permute(*d))(y, 0, 2, 1) + u * Dskip[None, None, :]
        return y

    def _B_ref(x, w1, b1, w2, b2):
        y = _layernorm(x, axis=-1)
        h = _gelu(torch.einsum("bsd,df->bsf", y, w1) + b1)
        return torch.einsum("bsf,fd->bsd", h, w2) + b2

    x = A_u
    xn = _layernorm(x, axis=-1)
    s = _A_ref(xn, A_A_re, A_A_im, A_B_re, A_B_im, A_C_re, A_C_im, A_log_dt, A_Dskip)
    g = _silu(_B_ref(xn, B_w1, B_b1, B_w2, B_b2))
    return x + s * g
```

```asm
; @launch grid=(224,1,1) block=(256,1,1) lds=161024
.amdgcn_target "amdgcn-amd-amdhsa--gfx950"
.text
.globl recurrent_scan__ssm_conv_s4__mixer_channel_mlp__prompt_kernel
.p2align 8
.type recurrent_scan__ssm_conv_s4__mixer_channel_mlp__prompt_kernel,@function
recurrent_scan__ssm_conv_s4__mixer_channel_mlp__prompt_kernel:
    s_load_dwordx16 s[4:19], s[0:1], 0
    s_load_dwordx16 s[20:35], s[0:1], 64
    s_load_dwordx2 s[36:37], s[0:1], 128
    s_cmp_ge_u32 s2, 224
    s_cbranch_scc1 END0
    s_getpc_b64 s[98:99]
PC0:
    s_lshl_b32 s73, s2, 11
    s_and_b32 s73, s73, 0x4000
    v_lshl_add_u32 v1, v0, 6, s73
    v_min_u32 v1, END-PC0, v1
    v_mov_b32 v3, s99
    v_add_co_u32_e64 v2, vcc, s98, v1
    v_addc_co_u32 v3, vcc, 0, v3, vcc
    global_load_dword a255, v[2:3], off
    s_lshl_b32 s73, s2, 10
    v_lshl_add_u32 v57, v0, 2, s73
    v_lshrrev_b32_e64 v1, 6, v0
    v_and_b32_e64 v0, 63, v0
    v_readfirstlane_b32 s70, v1
    s_and_b32 s73, s2, 1
    s_mul_i32 s73, s73, 28
    s_lshr_b32 s74, s2, 3
    s_add_u32 s73, s73, s74
    s_lshr_b32 s68, s73, 3
    s_and_b32 s90, s73, 7
    s_and_b32 s74, s2, 6
    s_lshl_b32 s74, s74, 2
    s_add_u32 s69, s90, s74
    v_lshrrev_b32_e64 v54, 3, v0
    v_and_b32_e64 v55, 7, v0
    v_mul_u32_u24 v14, 896, v54
    v_lshl_add_u32 v14, v55, 4, v14
    s_lshl_b32 s73, s69, 2
    s_add_u32 s73, s73, s70
    s_mul_i32 s73, s73, 14336
    v_add_u32 v14, s73, v14
    v_add_u32 v15, 7168, v14
    s_lshl_b32 s76, s68, 7
    s_add_u32 s77, s76, 384
    s_cmp_ge_u32 s77, 896
    s_cselect_b32 s74, 896, 0
    s_sub_u32 s77, s77, s74
    s_add_u32 s78, s77, 384
    s_cmp_ge_u32 s78, 896
    s_cselect_b32 s74, 896, 0
    s_sub_u32 s78, s78, s74
    s_add_u32 s79, s78, 384
    s_cmp_ge_u32 s79, 896
    s_cselect_b32 s74, 896, 0
    s_sub_u32 s79, s79, s74
    s_add_u32 s80, s79, 384
    s_cmp_ge_u32 s80, 896
    s_cselect_b32 s74, 896, 0
    s_sub_u32 s80, s80, s74
    s_add_u32 s81, s80, 384
    s_cmp_ge_u32 s81, 896
    s_cselect_b32 s74, 896, 0
    s_sub_u32 s81, s81, s74
    s_add_u32 s82, s81, 384
    s_cmp_ge_u32 s82, 896
    s_cselect_b32 s74, 896, 0
    s_sub_u32 s82, s82, s74
    v_mul_u32_u24 v1, 3584, v54
    v_lshl_add_u32 v16, v55, 6, v1
    s_lshr_b32 s74, s2, 3
    s_mul_i32 s39, s74, 37
    s_lshr_b32 s39, s39, 8
    s_mul_i32 s73, s39, 7
    s_sub_u32 s74, s74, s73
    s_lshl_b32 s74, s74, 2
    s_add_u32 s38, s74, s70
    s_and_b32 s73, s2, 1
    s_mul_i32 s73, s73, 3
    s_add_u32 s39, s39, s73
    s_mul_i32 s73, s38, 28672
    s_lshl_b32 s74, s39, 9
    s_add_u32 s73, s73, s74
    v_add_u32_e64 v16, s73, v16
    s_mul_i32 s73, s38, 28672
    s_lshl_b32 s74, s39, 7
    s_add_u32 s75, s73, s74
    s_mov_b32 s89, 802816
    s_mov_b32 s46, 1605632
    s_mov_b32 s47, 0x00020000
    s_mov_b32 s42, 1835008
    s_mov_b32 s43, 0x00020000
    s_lshl_b32 s74, s2, 2
    s_waitcnt lgkmcnt(0)
    global_load_dword v7, v57, s[6:7]
    global_load_dword v8, v57, s[8:9]
    global_load_dword v9, v57, s[10:11]
    global_load_dword v10, v57, s[12:13]
    global_load_dword v11, v57, s[14:15]
    global_load_dword v12, v57, s[16:17]
    s_load_dword s93, s[18:19], s74
    s_mov_b32 s40, s4
    s_mov_b32 s41, s5
    s_mov_b32 s44, s24
    s_mov_b32 s45, s25
    buffer_load_dwordx4 v[192:195], v14, s[40:43], s76 offen
    buffer_load_dwordx4 v[220:223], v15, s[40:43], s76 offen
    buffer_load_dwordx4 v[196:199], v14, s[40:43], s77 offen
    buffer_load_dwordx4 v[224:227], v15, s[40:43], s77 offen
    buffer_load_dwordx4 v[200:203], v14, s[40:43], s78 offen
    buffer_load_dwordx4 v[228:231], v15, s[40:43], s78 offen
    buffer_load_dword a255, v16, s[44:47], 0 offen
    s_memrealtime s[38:39]
    s_mov_b32 s3, 0xffff0000
    s_and_b32 s94, s70, 1
    s_lshr_b32 s95, s70, 1
    v_lshlrev_b32_e64 v13, 4, v0
    v_lshrrev_b32 v56, 5, v0
    s_lshl_b32 s14, s68, 7
    s_mov_b32 s52, s36
    s_mov_b32 s53, s37
    s_mov_b32 s54, 16777216
    s_mov_b32 s55, 0x00020000
    s_mov_b32 s64, s34
    s_mov_b32 s65, s35
    s_mov_b32 s66, 256
    s_mov_b32 s67, 0x00020000
    s_mov_b32 s48, s28
    s_mov_b32 s49, s29
    s_mov_b32 s50, 1605632
    s_mov_b32 s51, 0x00020000
    s_or_b32 s71, s2, s70
    s_cmp_lg_u32 s71, 0
    s_cbranch_scc1 NONCE
    s_waitcnt lgkmcnt(0)
    s_or_b32 s38, s38, 1
    v_mov_b32 v62, s38
    s_mov_b64 exec, 1
    buffer_store_dword v62, off, s[64:67], 0 sc1
    s_mov_b64 exec, -1
NONCE:
    v_lshrrev_b32_e64 v18, 1, v0
    v_mul_u32_u24 v18, 896, v18
    v_and_b32_e64 v57, 1, v0
    v_lshl_add_u32 v18, v57, 6, v18
    v_add_u32_e64 v18, s75, v18
    s_mov_b32 s6, 802816
    v_lshrrev_b32_e64 v57, 2, v0
    v_and_b32_e64 v57, 4, v57
    v_xor_b32_e64 v57, v57, v55
    v_lshlrev_b32_e64 v57, 4, v57
    v_mul_u32_u24 v2, 896, v54
    v_add_u32_e64 v2, v2, v57
    s_lshl_b32 s75, s68, 2
    s_add_u32 s75, s75, s70
    s_lshl_b32 s73, s75, 7
    v_add3_u32 v1, s73, v1, v57
    v_lshl_add_u32 v20, v56, 5, s73
    s_mul_i32 s73, s70, 57344
    s_add_u32 s73, s73, s14
    s_mul_i32 s72, s70, 20480
    s_add_u32 s72, s72, 79104
    s_lshl_b32 s4, s68, 5
    s_add_u32 s4, s4, s69
    s_lshl_b32 s4, s4, 4
    s_add_u32 s4, s4, 11534336
    s_lshl_b32 s5, s68, 18
    s_lshl_b32 s73, s69, 7
    s_add_u32 s5, s5, s73
    s_lshl_b32 s73, s70, 5
    s_add_u32 s5, s5, s73
    v_bfe_u32 v57, v0, 4, 1
    v_bfe_u32 v58, v0, 2, 2
    v_and_b32_e64 v59, 3, v0
    v_lshlrev_b32_e64 v61, 5, v57
    v_lshl_add_u32 v61, v59, 3, v61
    v_and_b32_e64 v40, 1, v0
    v_lshlrev_b32_e64 v40, 5, v40
    v_lshl_or_b32 v40, v57, 4, v40
    v_bfe_u32 v41, v0, 1, 1
    v_lshl_or_b32 v40, v41, 3, v40
    v_bfe_u32 v41, v0, 3, 1
    v_lshl_or_b32 v40, v41, 6, v40
    v_lshl_add_u32 v40, v58, 7, v40
    v_add_u32_e64 v40, s72, v40
    v_lshl_add_u32 v3, v56, 10, v40
    v_xor_b32 v4, 64, v3
    s_lshl_b32 s73, s94, 6
    v_xor_b32_e64 v60, s73, v3
    v_and_b32_e64 v40, 15, v0
    v_mul_u32_u24 v5, 912, v40
    v_mul_u32_u24 v24, 144, v40
    v_mul_u32_u24 v41, 17408, v57
    v_add_u32_e64 v5, v5, v41
    v_lshl_add_u32 v5, v56, 4, v5
    s_mul_i32 s73, s95, 34816
    s_sub_u32 s74, 34816, s73
    v_add_u32_e64 v6, s74, v5
    v_add_u32_e64 v5, s73, v5
    v_lshl_add_u32 v24, v56, 5, v24
    s_lshl_b32 s74, s94, 6
    s_add_u32 s73, s73, s74
    s_add_u32 s73, s73, 14592
    v_mul_u32_u24 v25, 2304, v57
    v_add_u32_e64 v25, v25, v24
    v_add3_u32 v24, v24, v41, s73
    s_mul_i32 s73, s95, 4608
    s_add_u32 s73, s73, s74
    s_add_u32 s73, s73, 69888
    v_add_u32 v25, s73, v25
    s_mul_i32 s75, s70, 17408
    v_mul_u32_u24 v21, 912, v54
    v_lshl_add_u32 v21, v55, 4, v21
    v_add_u32_e64 v21, s75, v21
    v_mul_u32_u24 v22, 144, v54
    v_lshl_add_u32 v22, v55, 4, v22
    s_mul_i32 s73, s70, 2304
    s_add_u32 s73, s73, 69888
    v_add_u32_e64 v23, s73, v22
    s_add_u32 s73, s75, 14592
    v_add_u32_e64 v22, s73, v22
    s_add_u32 s73, s72, 18432
    v_add_u32 v28, s73, v13
    s_xor_b32 s74, s70, 1
    s_mul_i32 s74, s74, 20480
    s_add_u32 s74, s74, 97536
    v_add_u32_e64 v29, s74, v13
    v_lshl_add_u32 v26, v57, 3, v58
    v_mul_u32_u24 v26, 144, v26
    v_lshl_add_u32 v26, v59, 3, v26
    v_lshl_add_u32 v26, v56, 5, v26
    s_mul_i32 s73, s70, 2304
    s_add_u32 s73, s73, 69888
    v_add_u32_e64 v26, s73, v26
    v_lshl_add_u32 v27, v56, 4, v40
    v_lshlrev_b32_e64 v27, 12, v27
    v_lshl_add_u32 v27, v57, 4, v27
    v_mul_u32_u24 v35, 272, v0
    v_add_u32 v35, s75, v35
    s_lshl_b32 s73, s94, 5
    v_add_u32_e64 v36, s73, v35
    v_subrev_u32_e64 v37, s73, v35
    v_bfe_u32 v41, v0, 3, 1
    v_lshl_add_u32 v41, v56, 2, v41
    v_mul_u32_u24 v41, 2176, v41
    v_bfe_u32 v38, v0, 2, 1
    v_lshl_add_u32 v38, v38, 6, v61
    v_add3_u32 v38, v38, v41, s75
    s_lshl_b32 s74, s95, 4
    s_waitcnt lgkmcnt(0)
    s_lshr_b32 s74, s93, s74
    s_lshl_b32 s74, s74, 16
    v_mov_b32 v39, 0x3fb8aa3b
    v_mul_f32_e64 v39, s74, v39
    v_exp_f32 v39, v39
    s_nop 0
    v_cvt_pk_bf16_f32 v39, v39, v39
    v_lshlrev_b32 v39, 16, v39
    s_waitcnt vmcnt(12)
    v_lshlrev_b32 v48, 16, v7
    s_waitcnt vmcnt(11)
    v_lshlrev_b32 v49, 16, v8
    s_waitcnt vmcnt(10)
    v_lshlrev_b32 v50, 16, v9
    s_waitcnt vmcnt(9)
    v_lshlrev_b32 v51, 16, v10
    s_waitcnt vmcnt(8)
    v_lshlrev_b32 v52, 16, v11
    s_waitcnt vmcnt(7)
    v_lshlrev_b32_e64 v53, 16, v12
    v_mul_f32_e64 v48, v39, v48
    v_mul_f32_e64 v49, v39, v49
    v_mul_f32_e64 v50, v39, v50
    v_mul_f32_e64 v51, v39, v51
    v_mul_f32 v46, 0x3fb8aa3b, v48
    v_mul_f32_e64 v47, 0.15915494, v49
    v_mul_f32_e64 v128, v52, v50
    v_mul_f32_e64 v129, v52, v51
    v_fma_f32 v128, -v53, v51, v128
    v_fma_f32 v129, v53, v50, v129
    v_mul_f32 v48, 0x41000000, v46
    v_mul_f32 v49, 0x41000000, v47
    v_mul_f32 v50, 0x43800000, v46
    v_mul_f32 v51, 0x43800000, v47
    v_fract_f32_e64 v47, v47
    v_exp_f32_e64 v46, v46
    v_fract_f32_e64 v49, v49
    v_exp_f32_e64 v48, v48
    v_fract_f32_e64 v51, v51
    v_exp_f32_e64 v50, v50
    v_cos_f32_e64 v40, v47
    v_sin_f32_e64 v41, v47
    v_cos_f32_e64 v66, v49
    v_sin_f32_e64 v67, v49
    v_cos_f32_e64 v42, v51
    v_sin_f32_e64 v43, v51
    v_mul_f32_e64 v40, v40, v46
    v_mul_f32_e64 v41, v41, v46
    v_mul_f32_e64 v66, v66, v48
    v_mul_f32_e64 v67, v67, v48
    v_mul_f32_e64 v42, v42, v50
    v_mul_f32_e64 v43, v43, v50
    v_mov_b32_e64 v64, 1.0
    v_mov_b32_e64 v65, 0
    v_pk_mul_f32 v[68:69], v[66:67], v[66:67] op_sel:[0,0] op_sel_hi:[0,1]
    v_pk_mul_f32 v[44:45], v[40:41], v[40:41] op_sel:[0,0] op_sel_hi:[0,1]
    v_pk_mul_f32 v[130:131], v[128:129], v[40:41] op_sel:[0,0] op_sel_hi:[0,1]
    v_pk_mul_f32 v[144:145], v[128:129], v[66:67] op_sel:[0,0] op_sel_hi:[0,1]
    v_pk_fma_f32 v[68:69], v[66:67], v[66:67], v[68:69] op_sel:[1,1,0] op_sel_hi:[1,0,1] neg_lo:[1,0,0]
    v_pk_fma_f32 v[44:45], v[40:41], v[40:41], v[44:45] op_sel:[1,1,0] op_sel_hi:[1,0,1] neg_lo:[1,0,0]
    v_pk_fma_f32 v[130:131], v[128:129], v[40:41], v[130:131] op_sel:[1,1,0] op_sel_hi:[1,0,1] neg_lo:[1,0,0]
    v_pk_fma_f32 v[144:145], v[128:129], v[66:67], v[144:145] op_sel:[1,1,0] op_sel_hi:[1,0,1] neg_lo:[1,0,0]
    v_pk_mul_f32 v[70:71], v[68:69], v[66:67] op_sel:[0,0] op_sel_hi:[0,1]
    v_pk_mul_f32 v[72:73], v[68:69], v[68:69] op_sel:[0,0] op_sel_hi:[0,1]
    v_pk_mul_f32 v[132:133], v[128:129], v[44:45] op_sel:[0,0] op_sel_hi:[0,1]
    v_pk_mul_f32 v[134:135], v[130:131], v[44:45] op_sel:[0,0] op_sel_hi:[0,1]
    v_pk_fma_f32 v[70:71], v[68:69], v[66:67], v[70:71] op_sel:[1,1,0] op_sel_hi:[1,0,1] neg_lo:[1,0,0]
    v_pk_fma_f32 v[72:73], v[68:69], v[68:69], v[72:73] op_sel:[1,1,0] op_sel_hi:[1,0,1] neg_lo:[1,0,0]
    v_pk_fma_f32 v[132:133], v[128:129], v[44:45], v[132:133] op_sel:[1,1,0] op_sel_hi:[1,0,1] neg_lo:[1,0,0]
    v_pk_fma_f32 v[134:135], v[130:131], v[44:45], v[134:135] op_sel:[1,1,0] op_sel_hi:[1,0,1] neg_lo:[1,0,0]
    v_pk_mul_f32 v[74:75], v[72:73], v[66:67] op_sel:[0,0] op_sel_hi:[0,1]
    v_pk_mul_f32 v[76:77], v[72:73], v[68:69] op_sel:[0,0] op_sel_hi:[0,1]
    v_pk_mul_f32 v[78:79], v[72:73], v[70:71] op_sel:[0,0] op_sel_hi:[0,1]
    v_pk_mul_f32 v[80:81], v[72:73], v[72:73] op_sel:[0,0] op_sel_hi:[0,1]
    v_pk_mul_f32 v[136:137], v[132:133], v[44:45] op_sel:[0,0] op_sel_hi:[0,1]
    v_pk_mul_f32 v[138:139], v[134:135], v[44:45] op_sel:[0,0] op_sel_hi:[0,1]
    v_pk_fma_f32 v[74:75], v[72:73], v[66:67], v[74:75] op_sel:[1,1,0] op_sel_hi:[1,0,1] neg_lo:[1,0,0]
    v_pk_fma_f32 v[76:77], v[72:73], v[68:69], v[76:77] op_sel:[1,1,0] op_sel_hi:[1,0,1] neg_lo:[1,0,0]
    v_pk_fma_f32 v[78:79], v[72:73], v[70:71], v[78:79] op_sel:[1,1,0] op_sel_hi:[1,0,1] neg_lo:[1,0,0]
    v_pk_fma_f32 v[80:81], v[72:73], v[72:73], v[80:81] op_sel:[1,1,0] op_sel_hi:[1,0,1] neg_lo:[1,0,0]
    v_pk_fma_f32 v[136:137], v[132:133], v[44:45], v[136:137] op_sel:[1,1,0] op_sel_hi:[1,0,1] neg_lo:[1,0,0]
    v_pk_fma_f32 v[138:139], v[134:135], v[44:45], v[138:139] op_sel:[1,1,0] op_sel_hi:[1,0,1] neg_lo:[1,0,0]
    v_cvt_pk_bf16_f32 v156, v64, v66
    v_cvt_pk_bf16_f32 v157, v68, v70
    v_cvt_pk_bf16_f32 v158, v72, v74
    v_cvt_pk_bf16_f32 v159, v76, v78
    v_cvt_pk_bf16_f32 v160, v65, v67
    v_cvt_pk_bf16_f32 v161, v69, v71
    v_cvt_pk_bf16_f32 v162, v73, v75
    v_cvt_pk_bf16_f32 v163, v77, v79
    ds_write_b128 v35, v[156:159] offset:128
    ds_write_b128 v35, v[160:163] offset:192
    buffer_load_dword a255, v16, s[44:47], s89 offen
    v_pk_mul_f32 v[82:83], v[80:81], v[66:67] op_sel:[0,0] op_sel_hi:[0,1]
    v_pk_mul_f32 v[84:85], v[80:81], v[68:69] op_sel:[0,0] op_sel_hi:[0,1]
    v_pk_mul_f32 v[86:87], v[80:81], v[70:71] op_sel:[0,0] op_sel_hi:[0,1]
    v_pk_mul_f32 v[88:89], v[80:81], v[72:73] op_sel:[0,0] op_sel_hi:[0,1]
    v_pk_mul_f32 v[90:91], v[80:81], v[74:75] op_sel:[0,0] op_sel_hi:[0,1]
    v_pk_mul_f32 v[92:93], v[80:81], v[76:77] op_sel:[0,0] op_sel_hi:[0,1]
    v_pk_mul_f32 v[94:95], v[80:81], v[78:79] op_sel:[0,0] op_sel_hi:[0,1]
    v_pk_mul_f32 v[96:97], v[80:81], v[80:81] op_sel:[0,0] op_sel_hi:[0,1]
    v_pk_mul_f32 v[140:141], v[136:137], v[44:45] op_sel:[0,0] op_sel_hi:[0,1]
    v_pk_mul_f32 v[142:143], v[138:139], v[44:45] op_sel:[0,0] op_sel_hi:[0,1]
    v_pk_fma_f32 v[82:83], v[80:81], v[66:67], v[82:83] op_sel:[1,1,0] op_sel_hi:[1,0,1] neg_lo:[1,0,0]
    v_pk_fma_f32 v[84:85], v[80:81], v[68:69], v[84:85] op_sel:[1,1,0] op_sel_hi:[1,0,1] neg_lo:[1,0,0]
    v_pk_fma_f32 v[86:87], v[80:81], v[70:71], v[86:87] op_sel:[1,1,0] op_sel_hi:[1,0,1] neg_lo:[1,0,0]
    v_pk_fma_f32 v[88:89], v[80:81], v[72:73], v[88:89] op_sel:[1,1,0] op_sel_hi:[1,0,1] neg_lo:[1,0,0]
    v_pk_fma_f32 v[90:91], v[80:81], v[74:75], v[90:91] op_sel:[1,1,0] op_sel_hi:[1,0,1] neg_lo:[1,0,0]
    v_pk_fma_f32 v[92:93], v[80:81], v[76:77], v[92:93] op_sel:[1,1,0] op_sel_hi:[1,0,1] neg_lo:[1,0,0]
    v_pk_fma_f32 v[94:95], v[80:81], v[78:79], v[94:95] op_sel:[1,1,0] op_sel_hi:[1,0,1] neg_lo:[1,0,0]
    v_pk_fma_f32 v[96:97], v[80:81], v[80:81], v[96:97] op_sel:[1,1,0] op_sel_hi:[1,0,1] neg_lo:[1,0,0]
    v_pk_fma_f32 v[140:141], v[136:137], v[44:45], v[140:141] op_sel:[1,1,0] op_sel_hi:[1,0,1] neg_lo:[1,0,0]
    v_pk_fma_f32 v[142:143], v[138:139], v[44:45], v[142:143] op_sel:[1,1,0] op_sel_hi:[1,0,1] neg_lo:[1,0,0]
    v_cvt_pk_bf16_f32 v164, v80, v82
    v_cvt_pk_bf16_f32 v165, v84, v86
    v_cvt_pk_bf16_f32 v166, v88, v90
    v_cvt_pk_bf16_f32 v167, v92, v94
    v_cvt_pk_bf16_f32 v168, v81, v83
    v_cvt_pk_bf16_f32 v169, v85, v87
    v_cvt_pk_bf16_f32 v170, v89, v91
    v_cvt_pk_bf16_f32 v171, v93, v95
    ds_write_b128 v35, v[164:167] offset:144
    ds_write_b128 v35, v[168:171] offset:208
    buffer_load_dwordx4 v[204:207], v14, s[40:43], s79 offen
    v_pk_mul_f32 v[98:99], v[96:97], v[66:67] op_sel:[0,0] op_sel_hi:[0,1]
    v_pk_mul_f32 v[100:101], v[96:97], v[68:69] op_sel:[0,0] op_sel_hi:[0,1]
    v_pk_mul_f32 v[102:103], v[96:97], v[70:71] op_sel:[0,0] op_sel_hi:[0,1]
    v_pk_mul_f32 v[104:105], v[96:97], v[72:73] op_sel:[0,0] op_sel_hi:[0,1]
    v_pk_mul_f32 v[106:107], v[96:97], v[74:75] op_sel:[0,0] op_sel_hi:[0,1]
    v_pk_mul_f32 v[108:109], v[96:97], v[76:77] op_sel:[0,0] op_sel_hi:[0,1]
    v_pk_mul_f32 v[110:111], v[96:97], v[78:79] op_sel:[0,0] op_sel_hi:[0,1]
    v_pk_mul_f32 v[146:147], v[128:129], v[42:43] op_sel:[0,0] op_sel_hi:[0,1]
    v_pk_mul_f32 v[148:149], v[132:133], v[42:43] op_sel:[0,0] op_sel_hi:[0,1]
    v_pk_mul_f32 v[150:151], v[136:137], v[42:43] op_sel:[0,0] op_sel_hi:[0,1]
    v_pk_mul_f32 v[152:153], v[140:141], v[42:43] op_sel:[0,0] op_sel_hi:[0,1]
    v_pk_mul_f32 v[154:155], v[144:145], v[42:43] op_sel:[0,0] op_sel_hi:[0,1]
    v_pk_fma_f32 v[98:99], v[96:97], v[66:67], v[98:99] op_sel:[1,1,0] op_sel_hi:[1,0,1] neg_lo:[1,0,0]
    v_pk_fma_f32 v[100:101], v[96:97], v[68:69], v[100:101] op_sel:[1,1,0] op_sel_hi:[1,0,1] neg_lo:[1,0,0]
    v_pk_fma_f32 v[102:103], v[96:97], v[70:71], v[102:103] op_sel:[1,1,0] op_sel_hi:[1,0,1] neg_lo:[1,0,0]
    v_pk_fma_f32 v[104:105], v[96:97], v[72:73], v[104:105] op_sel:[1,1,0] op_sel_hi:[1,0,1] neg_lo:[1,0,0]
    v_pk_fma_f32 v[106:107], v[96:97], v[74:75], v[106:107] op_sel:[1,1,0] op_sel_hi:[1,0,1] neg_lo:[1,0,0]
    v_pk_fma_f32 v[108:109], v[96:97], v[76:77], v[108:109] op_sel:[1,1,0] op_sel_hi:[1,0,1] neg_lo:[1,0,0]
    v_pk_fma_f32 v[110:111], v[96:97], v[78:79], v[110:111] op_sel:[1,1,0] op_sel_hi:[1,0,1] neg_lo:[1,0,0]
    v_pk_fma_f32 v[146:147], v[128:129], v[42:43], v[146:147] op_sel:[1,1,0] op_sel_hi:[1,0,1] neg_lo:[1,0,0]
    v_pk_fma_f32 v[148:149], v[132:133], v[42:43], v[148:149] op_sel:[1,1,0] op_sel_hi:[1,0,1] neg_lo:[1,0,0]
    v_pk_fma_f32 v[150:151], v[136:137], v[42:43], v[150:151] op_sel:[1,1,0] op_sel_hi:[1,0,1] neg_lo:[1,0,0]
    v_pk_fma_f32 v[152:153], v[140:141], v[42:43], v[152:153] op_sel:[1,1,0] op_sel_hi:[1,0,1] neg_lo:[1,0,0]
    v_pk_fma_f32 v[154:155], v[144:145], v[42:43], v[154:155] op_sel:[1,1,0] op_sel_hi:[1,0,1] neg_lo:[1,0,0]
    v_cvt_pk_bf16_f32 v156, v96, v98
    v_cvt_pk_bf16_f32 v157, v100, v102
    v_cvt_pk_bf16_f32 v158, v104, v106
    v_cvt_pk_bf16_f32 v159, v108, v110
    v_cvt_pk_bf16_f32 v160, v97, v99
    v_cvt_pk_bf16_f32 v161, v101, v103
    v_cvt_pk_bf16_f32 v162, v105, v107
    v_cvt_pk_bf16_f32 v163, v109, v111
    ds_write_b128 v35, v[156:159] offset:160
    ds_write_b128 v35, v[160:163] offset:224
    buffer_load_dwordx4 v[232:235], v15, s[40:43], s79 offen
    v_pk_mul_f32 v[112:113], v[96:97], v[80:81] op_sel:[0,0] op_sel_hi:[0,1]
    v_pk_mul_f32 v[114:115], v[96:97], v[82:83] op_sel:[0,0] op_sel_hi:[0,1]
    v_pk_mul_f32 v[116:117], v[96:97], v[84:85] op_sel:[0,0] op_sel_hi:[0,1]
    v_pk_mul_f32 v[118:119], v[96:97], v[86:87] op_sel:[0,0] op_sel_hi:[0,1]
    v_pk_mul_f32 v[120:121], v[96:97], v[88:89] op_sel:[0,0] op_sel_hi:[0,1]
    v_pk_mul_f32 v[122:123], v[96:97], v[90:91] op_sel:[0,0] op_sel_hi:[0,1]
    v_pk_mul_f32 v[124:125], v[96:97], v[92:93] op_sel:[0,0] op_sel_hi:[0,1]
    v_pk_mul_f32 v[126:127], v[96:97], v[94:95] op_sel:[0,0] op_sel_hi:[0,1]
    v_pk_mul_f32 v[66:67], v[146:147], v[42:43] op_sel:[0,0] op_sel_hi:[0,1]
    v_pk_mul_f32 v[68:69], v[150:151], v[42:43] op_sel:[0,0] op_sel_hi:[0,1]
    v_pk_mul_f32 v[70:71], v[154:155], v[42:43] op_sel:[0,0] op_sel_hi:[0,1]
    v_pk_fma_f32 v[112:113], v[96:97], v[80:81], v[112:113] op_sel:[1,1,0] op_sel_hi:[1,0,1] neg_lo:[1,0,0]
    v_pk_fma_f32 v[114:115], v[96:97], v[82:83], v[114:115] op_sel:[1,1,0] op_sel_hi:[1,0,1] neg_lo:[1,0,0]
    v_pk_fma_f32 v[116:117], v[96:97], v[84:85], v[116:117] op_sel:[1,1,0] op_sel_hi:[1,0,1] neg_lo:[1,0,0]
    v_pk_fma_f32 v[118:119], v[96:97], v[86:87], v[118:119] op_sel:[1,1,0] op_sel_hi:[1,0,1] neg_lo:[1,0,0]
    v_pk_fma_f32 v[120:121], v[96:97], v[88:89], v[120:121] op_sel:[1,1,0] op_sel_hi:[1,0,1] neg_lo:[1,0,0]
    v_pk_fma_f32 v[122:123], v[96:97], v[90:91], v[122:123] op_sel:[1,1,0] op_sel_hi:[1,0,1] neg_lo:[1,0,0]
    v_pk_fma_f32 v[124:125], v[96:97], v[92:93], v[124:125] op_sel:[1,1,0] op_sel_hi:[1,0,1] neg_lo:[1,0,0]
    v_pk_fma_f32 v[126:127], v[96:97], v[94:95], v[126:127] op_sel:[1,1,0] op_sel_hi:[1,0,1] neg_lo:[1,0,0]
    v_pk_fma_f32 v[66:67], v[146:147], v[42:43], v[66:67] op_sel:[1,1,0] op_sel_hi:[1,0,1] neg_lo:[1,0,0]
    v_pk_fma_f32 v[68:69], v[150:151], v[42:43], v[68:69] op_sel:[1,1,0] op_sel_hi:[1,0,1] neg_lo:[1,0,0]
    v_pk_fma_f32 v[70:71], v[154:155], v[42:43], v[70:71] op_sel:[1,1,0] op_sel_hi:[1,0,1] neg_lo:[1,0,0]
    v_cvt_pk_bf16_f32 v164, v112, v114
    v_cvt_pk_bf16_f32 v165, v116, v118
    v_cvt_pk_bf16_f32 v166, v120, v122
    v_cvt_pk_bf16_f32 v167, v124, v126
    v_cvt_pk_bf16_f32 v168, v113, v115
    v_cvt_pk_bf16_f32 v169, v117, v119
    v_cvt_pk_bf16_f32 v170, v121, v123
    v_cvt_pk_bf16_f32 v171, v125, v127
    ds_write_b128 v35, v[164:167] offset:176
    ds_write_b128 v35, v[168:171] offset:240
    buffer_load_dwordx4 v[208:211], v14, s[40:43], s80 offen
    v_pk_mul_f32 v[72:73], v[66:67], v[42:43] op_sel:[0,0] op_sel_hi:[0,1]
    v_pk_mul_f32 v[74:75], v[68:69], v[42:43] op_sel:[0,0] op_sel_hi:[0,1]
    v_pk_mul_f32 v[76:77], v[70:71], v[42:43] op_sel:[0,0] op_sel_hi:[0,1]
    v_pk_fma_f32 v[72:73], v[66:67], v[42:43], v[72:73] op_sel:[1,1,0] op_sel_hi:[1,0,1] neg_lo:[1,0,0]
    v_pk_fma_f32 v[74:75], v[68:69], v[42:43], v[74:75] op_sel:[1,1,0] op_sel_hi:[1,0,1] neg_lo:[1,0,0]
    v_pk_fma_f32 v[76:77], v[70:71], v[42:43], v[76:77] op_sel:[1,1,0] op_sel_hi:[1,0,1] neg_lo:[1,0,0]
    v_cvt_pk_bf16_f32 v156, v128, v130
    v_cvt_pk_bf16_f32 v157, v132, v134
    v_cvt_pk_bf16_f32 v158, v146, v146
    v_cvt_pk_bf16_f32 v159, v148, v150
    v_cvt_pk_bf16_f32 v160, -v129, -v131
    v_cvt_pk_bf16_f32 v161, -v133, -v135
    v_cvt_pk_bf16_f32 v162, -v147, -v147
    v_cvt_pk_bf16_f32 v163, -v149, -v151
    ds_write_b128 v36, v[156:159] offset:0
    ds_write_b128 v36, v[160:163] offset:64
    buffer_load_dwordx4 v[236:239], v15, s[40:43], s80 offen
    v_pk_mul_f32 v[80:81], v[72:73], v[42:43] op_sel:[0,0] op_sel_hi:[0,1]
    v_pk_mul_f32 v[82:83], v[76:77], v[42:43] op_sel:[0,0] op_sel_hi:[0,1]
    v_pk_fma_f32 v[80:81], v[72:73], v[42:43], v[80:81] op_sel:[1,1,0] op_sel_hi:[1,0,1] neg_lo:[1,0,0]
    v_pk_fma_f32 v[82:83], v[76:77], v[42:43], v[82:83] op_sel:[1,1,0] op_sel_hi:[1,0,1] neg_lo:[1,0,0]
    v_pk_mul_f32 v[84:85], v[80:81], v[42:43] op_sel:[0,0] op_sel_hi:[0,1]
    v_pk_mul_f32 v[86:87], v[82:83], v[42:43] op_sel:[0,0] op_sel_hi:[0,1]
    v_pk_fma_f32 v[84:85], v[80:81], v[42:43], v[84:85] op_sel:[1,1,0] op_sel_hi:[1,0,1] neg_lo:[1,0,0]
    v_pk_fma_f32 v[86:87], v[82:83], v[42:43], v[86:87] op_sel:[1,1,0] op_sel_hi:[1,0,1] neg_lo:[1,0,0]
    v_cvt_pk_bf16_f32 v164, v136, v138
    v_cvt_pk_bf16_f32 v165, v140, v142
    v_cvt_pk_bf16_f32 v166, v150, v150
    v_cvt_pk_bf16_f32 v167, v152, v154
    v_cvt_pk_bf16_f32 v168, -v137, -v139
    v_cvt_pk_bf16_f32 v169, -v141, -v143
    v_cvt_pk_bf16_f32 v170, -v151, -v151
    v_cvt_pk_bf16_f32 v171, -v153, -v155
    ds_write_b128 v36, v[164:167] offset:16
    ds_write_b128 v36, v[168:171] offset:80
    buffer_load_dwordx4 v[212:215], v14, s[40:43], s81 offen
    v_pk_mul_f32 v[88:89], v[84:85], v[42:43] op_sel:[0,0] op_sel_hi:[0,1]
    v_pk_mul_f32 v[90:91], v[86:87], v[42:43] op_sel:[0,0] op_sel_hi:[0,1]
    v_pk_fma_f32 v[88:89], v[84:85], v[42:43], v[88:89] op_sel:[1,1,0] op_sel_hi:[1,0,1] neg_lo:[1,0,0]
    v_pk_fma_f32 v[90:91], v[86:87], v[42:43], v[90:91] op_sel:[1,1,0] op_sel_hi:[1,0,1] neg_lo:[1,0,0]
    v_cvt_pk_bf16_f32 v156, v66, v68
    v_cvt_pk_bf16_f32 v157, v70, v80
    v_cvt_pk_bf16_f32 v158, v72, v74
    v_cvt_pk_bf16_f32 v159, v76, v88
    v_cvt_pk_bf16_f32 v160, -v67, -v69
    v_cvt_pk_bf16_f32 v161, -v71, -v81
    v_cvt_pk_bf16_f32 v162, -v73, -v75
    v_cvt_pk_bf16_f32 v163, -v77, -v89
    ds_write_b128 v37, v[156:159] offset:32
    ds_write_b128 v37, v[160:163] offset:96
    buffer_load_dwordx4 v[240:243], v15, s[40:43], s81 offen
    v_pk_mul_f32 v[92:93], v[88:89], v[42:43] op_sel:[0,0] op_sel_hi:[0,1]
    v_pk_mul_f32 v[94:95], v[90:91], v[42:43] op_sel:[0,0] op_sel_hi:[0,1]
    v_pk_fma_f32 v[92:93], v[88:89], v[42:43], v[92:93] op_sel:[1,1,0] op_sel_hi:[1,0,1] neg_lo:[1,0,0]
    v_pk_fma_f32 v[94:95], v[90:91], v[42:43], v[94:95] op_sel:[1,1,0] op_sel_hi:[1,0,1] neg_lo:[1,0,0]
    v_cvt_pk_bf16_f32 v164, v82, v84
    v_cvt_pk_bf16_f32 v165, v86, v86
    v_cvt_pk_bf16_f32 v166, v90, v92
    v_cvt_pk_bf16_f32 v167, v94, v94
    v_cvt_pk_bf16_f32 v168, -v83, -v85
    v_cvt_pk_bf16_f32 v169, -v87, -v87
    v_cvt_pk_bf16_f32 v170, -v91, -v93
    v_cvt_pk_bf16_f32 v171, -v95, -v95
    ds_write_b128 v37, v[164:167] offset:48
    ds_write_b128 v37, v[168:171] offset:112
    buffer_load_dwordx4 v[216:219], v14, s[40:43], s82 offen
    ds_read_b64_tr_b16 a[0:1], v38 offset:0
    ds_read_b64_tr_b16 a[2:3], v38 offset:4352
    ds_read_b64_tr_b16 a[4:5], v38 offset:128
    ds_read_b64_tr_b16 a[6:7], v38 offset:4480
    ds_read_b64_tr_b16 a[8:9], v38 offset:272
    ds_read_b64_tr_b16 a[10:11], v38 offset:4624
    ds_read_b64_tr_b16 a[12:13], v38 offset:400
    ds_read_b64_tr_b16 a[14:15], v38 offset:4752
    v_and_b32_e64 v48, s3, v7
    v_and_b32_e64 v49, s3, v8
    v_and_b32_e64 v50, s3, v9
    v_and_b32_e64 v51, s3, v10
    v_and_b32_e64 v52, s3, v11
    v_and_b32_e64 v53, s3, v12
    v_mul_f32_e64 v48, v39, v48
    v_mul_f32_e64 v49, v39, v49
    v_mul_f32_e64 v50, v39, v50
    v_mul_f32_e64 v51, v39, v51
    v_mul_f32 v46, 0x3fb8aa3b, v48
    v_mul_f32 v47, 0.15915494, v49
    s_waitcnt lgkmcnt(4)
    v_mfma_f32_32x32x16_bf16 a[208:223], a[0:3], a[4:7], 0
    ds_read_b64_tr_b16 a[16:17], v38 offset:544
    ds_read_b64_tr_b16 a[18:19], v38 offset:4896
    ds_read_b64_tr_b16 a[20:21], v38 offset:672
    ds_read_b64_tr_b16 a[22:23], v38 offset:5024
    v_mul_f32_e64 v128, v52, v50
    v_mul_f32 v129, v52, v51
    v_fma_f32 v128, -v53, v51, v128
    s_waitcnt lgkmcnt(4)
    v_mfma_f32_32x32x16_bf16 a[208:223], a[8:11], a[12:15], a[208:223]
    ds_read_b64_tr_b16 a[24:25], v38 offset:816
    ds_read_b64_tr_b16 a[26:27], v38 offset:5168
    ds_read_b64_tr_b16 a[28:29], v38 offset:944
    ds_read_b64_tr_b16 a[30:31], v38 offset:5296
    v_fma_f32 v129, v53, v50, v129
    v_mul_f32 v48, 0x41000000, v46
    v_mul_f32 v49, 0x41000000, v47
    s_waitcnt lgkmcnt(4)
    s_nop 0
    v_mfma_f32_32x32x16_bf16 a[208:223], a[16:19], a[20:23], a[208:223]
    ds_read_b64_tr_b16 a[32:33], v38 offset:1088
    ds_read_b64_tr_b16 a[34:35], v38 offset:5440
    ds_read_b64_tr_b16 a[36:37], v38 offset:1216
    ds_read_b64_tr_b16 a[38:39], v38 offset:5568
    buffer_load_dwordx4 v[244:247], v15, s[40:43], s82 offen
    v_mul_f32 v50, 0x43800000, v46
    v_mul_f32 v51, 0x43800000, v47
    v_fract_f32 v47, v47
    s_waitcnt lgkmcnt(4)
    v_mfma_f32_32x32x16_bf16 a[208:223], a[24:27], a[28:31], a[208:223]
    ds_read_b64_tr_b16 a[40:41], v38 offset:1360
    ds_read_b64_tr_b16 a[42:43], v38 offset:5712
    ds_read_b64_tr_b16 a[44:45], v38 offset:1488
    ds_read_b64_tr_b16 a[46:47], v38 offset:5840
    v_exp_f32_e64 v46, v46
    v_fract_f32_e64 v49, v49
    v_exp_f32 v48, v48
    s_waitcnt lgkmcnt(4)
    v_mfma_f32_32x32x16_bf16 a[208:223], a[32:35], a[36:39], a[208:223]
    ds_read_b64_tr_b16 a[48:49], v38 offset:1632
    ds_read_b64_tr_b16 a[50:51], v38 offset:5984
    ds_read_b64_tr_b16 a[52:53], v38 offset:1760
    ds_read_b64_tr_b16 a[54:55], v38 offset:6112
    v_fract_f32_e64 v51, v51
    v_exp_f32_e64 v50, v50
    v_cos_f32 v40, v47
    s_waitcnt lgkmcnt(4)
    v_mfma_f32_32x32x16_bf16 a[208:223], a[40:43], a[44:47], a[208:223]
    ds_read_b64_tr_b16 a[56:57], v38 offset:1904
    ds_read_b64_tr_b16 a[58:59], v38 offset:6256
    ds_read_b64_tr_b16 a[60:61], v38 offset:2032
    ds_read_b64_tr_b16 a[62:63], v38 offset:6384
    v_sin_f32_e64 v41, v47
    v_cos_f32_e64 v66, v49
    v_sin_f32 v67, v49
    s_waitcnt lgkmcnt(4)
    v_mfma_f32_32x32x16_bf16 a[208:223], a[48:51], a[52:55], a[208:223]
    buffer_load_dword a255, v18, s[48:51], 0 offen
    v_cos_f32_e64 v42, v51
    v_sin_f32_e64 v43, v51
    v_mul_f32_e64 v40, v40, v46
    v_mul_f32_e64 v41, v41, v46
    v_mul_f32 v66, v66, v48
    s_waitcnt lgkmcnt(0)
    v_mfma_f32_32x32x16_bf16 a[208:223], a[56:59], a[60:63], a[208:223]
    v_mul_f32_e64 v67, v67, v48
    v_mul_f32_e64 v42, v42, v50
    v_mul_f32_e64 v43, v43, v50
    v_pk_mul_f32 v[68:69], v[66:67], v[66:67] op_sel:[0,0] op_sel_hi:[0,1]
    v_pk_mul_f32 v[44:45], v[40:41], v[40:41] op_sel:[0,0] op_sel_hi:[0,1]
    v_pk_mul_f32 v[130:131], v[128:129], v[40:41] op_sel:[0,0] op_sel_hi:[0,1]
    v_pk_mul_f32 v[144:145], v[128:129], v[66:67] op_sel:[0,0] op_sel_hi:[0,1]
    v_pk_fma_f32 v[68:69], v[66:67], v[66:67], v[68:69] op_sel:[1,1,0] op_sel_hi:[1,0,1] neg_lo:[1,0,0]
    v_pk_fma_f32 v[44:45], v[40:41], v[40:41], v[44:45] op_sel:[1,1,0] op_sel_hi:[1,0,1] neg_lo:[1,0,0]
    v_pk_fma_f32 v[130:131], v[128:129], v[40:41], v[130:131] op_sel:[1,1,0] op_sel_hi:[1,0,1] neg_lo:[1,0,0]
    v_pk_fma_f32 v[144:145], v[128:129], v[66:67], v[144:145] op_sel:[1,1,0] op_sel_hi:[1,0,1] neg_lo:[1,0,0]
    v_pk_mul_f32 v[70:71], v[68:69], v[66:67] op_sel:[0,0] op_sel_hi:[0,1]
    v_pk_mul_f32 v[72:73], v[68:69], v[68:69] op_sel:[0,0] op_sel_hi:[0,1]
    v_pk_mul_f32 v[132:133], v[128:129], v[44:45] op_sel:[0,0] op_sel_hi:[0,1]
    v_pk_mul_f32 v[134:135], v[130:131], v[44:45] op_sel:[0,0] op_sel_hi:[0,1]
    v_pk_fma_f32 v[70:71], v[68:69], v[66:67], v[70:71] op_sel:[1,1,0] op_sel_hi:[1,0,1] neg_lo:[1,0,0]
    v_pk_fma_f32 v[72:73], v[68:69], v[68:69], v[72:73] op_sel:[1,1,0] op_sel_hi:[1,0,1] neg_lo:[1,0,0]
    v_pk_fma_f32 v[132:133], v[128:129], v[44:45], v[132:133] op_sel:[1,1,0] op_sel_hi:[1,0,1] neg_lo:[1,0,0]
    v_pk_fma_f32 v[134:135], v[130:131], v[44:45], v[134:135] op_sel:[1,1,0] op_sel_hi:[1,0,1] neg_lo:[1,0,0]
    v_pk_mul_f32 v[74:75], v[72:73], v[66:67] op_sel:[0,0] op_sel_hi:[0,1]
    v_pk_mul_f32 v[76:77], v[72:73], v[68:69] op_sel:[0,0] op_sel_hi:[0,1]
    v_pk_mul_f32 v[78:79], v[72:73], v[70:71] op_sel:[0,0] op_sel_hi:[0,1]
    v_pk_mul_f32 v[80:81], v[72:73], v[72:73] op_sel:[0,0] op_sel_hi:[0,1]
    v_pk_mul_f32 v[136:137], v[132:133], v[44:45] op_sel:[0,0] op_sel_hi:[0,1]
    v_pk_mul_f32 v[138:139], v[134:135], v[44:45] op_sel:[0,0] op_sel_hi:[0,1]
    v_pk_fma_f32 v[74:75], v[72:73], v[66:67], v[74:75] op_sel:[1,1,0] op_sel_hi:[1,0,1] neg_lo:[1,0,0]
    v_pk_fma_f32 v[76:77], v[72:73], v[68:69], v[76:77] op_sel:[1,1,0] op_sel_hi:[1,0,1] neg_lo:[1,0,0]
    v_pk_fma_f32 v[78:79], v[72:73], v[70:71], v[78:79] op_sel:[1,1,0] op_sel_hi:[1,0,1] neg_lo:[1,0,0]
    v_pk_fma_f32 v[80:81], v[72:73], v[72:73], v[80:81] op_sel:[1,1,0] op_sel_hi:[1,0,1] neg_lo:[1,0,0]
    v_pk_fma_f32 v[136:137], v[132:133], v[44:45], v[136:137] op_sel:[1,1,0] op_sel_hi:[1,0,1] neg_lo:[1,0,0]
    v_pk_fma_f32 v[138:139], v[134:135], v[44:45], v[138:139] op_sel:[1,1,0] op_sel_hi:[1,0,1] neg_lo:[1,0,0]
    v_cvt_pk_bf16_f32 v156, v64, v66
    v_cvt_pk_bf16_f32 v157, v68, v70
    v_cvt_pk_bf16_f32 v158, v72, v74
    v_cvt_pk_bf16_f32 v159, v76, v78
    v_cvt_pk_bf16_f32 v160, v65, v67
    v_cvt_pk_bf16_f32 v161, v69, v71
    v_cvt_pk_bf16_f32 v162, v73, v75
    v_cvt_pk_bf16_f32 v163, v77, v79
    ds_write_b128 v35, v[156:159] offset:128
    ds_write_b128 v35, v[160:163] offset:192
    v_pk_mul_f32 v[82:83], v[80:81], v[66:67] op_sel:[0,0] op_sel_hi:[0,1]
    v_pk_mul_f32 v[84:85], v[80:81], v[68:69] op_sel:[0,0] op_sel_hi:[0,1]
    v_pk_mul_f32 v[86:87], v[80:81], v[70:71] op_sel:[0,0] op_sel_hi:[0,1]
    v_pk_mul_f32 v[88:89], v[80:81], v[72:73] op_sel:[0,0] op_sel_hi:[0,1]
    v_pk_mul_f32 v[90:91], v[80:81], v[74:75] op_sel:[0,0] op_sel_hi:[0,1]
    v_pk_mul_f32 v[92:93], v[80:81], v[76:77] op_sel:[0,0] op_sel_hi:[0,1]
    v_pk_mul_f32 v[94:95], v[80:81], v[78:79] op_sel:[0,0] op_sel_hi:[0,1]
    v_pk_mul_f32 v[96:97], v[80:81], v[80:81] op_sel:[0,0] op_sel_hi:[0,1]
    v_pk_mul_f32 v[140:141], v[136:137], v[44:45] op_sel:[0,0] op_sel_hi:[0,1]
    v_pk_mul_f32 v[142:143], v[138:139], v[44:45] op_sel:[0,0] op_sel_hi:[0,1]
    v_pk_fma_f32 v[82:83], v[80:81], v[66:67], v[82:83] op_sel:[1,1,0] op_sel_hi:[1,0,1] neg_lo:[1,0,0]
    v_pk_fma_f32 v[84:85], v[80:81], v[68:69], v[84:85] op_sel:[1,1,0] op_sel_hi:[1,0,1] neg_lo:[1,0,0]
    v_pk_fma_f32 v[86:87], v[80:81], v[70:71], v[86:87] op_sel:[1,1,0] op_sel_hi:[1,0,1] neg_lo:[1,0,0]
    v_pk_fma_f32 v[88:89], v[80:81], v[72:73], v[88:89] op_sel:[1,1,0] op_sel_hi:[1,0,1] neg_lo:[1,0,0]
    v_pk_fma_f32 v[90:91], v[80:81], v[74:75], v[90:91] op_sel:[1,1,0] op_sel_hi:[1,0,1] neg_lo:[1,0,0]
    v_pk_fma_f32 v[92:93], v[80:81], v[76:77], v[92:93] op_sel:[1,1,0] op_sel_hi:[1,0,1] neg_lo:[1,0,0]
    v_pk_fma_f32 v[94:95], v[80:81], v[78:79], v[94:95] op_sel:[1,1,0] op_sel_hi:[1,0,1] neg_lo:[1,0,0]
    v_pk_fma_f32 v[96:97], v[80:81], v[80:81], v[96:97] op_sel:[1,1,0] op_sel_hi:[1,0,1] neg_lo:[1,0,0]
    v_pk_fma_f32 v[140:141], v[136:137], v[44:45], v[140:141] op_sel:[1,1,0] op_sel_hi:[1,0,1] neg_lo:[1,0,0]
    v_pk_fma_f32 v[142:143], v[138:139], v[44:45], v[142:143] op_sel:[1,1,0] op_sel_hi:[1,0,1] neg_lo:[1,0,0]
    v_cvt_pk_bf16_f32 v164, v80, v82
    v_cvt_pk_bf16_f32 v165, v84, v86
    v_cvt_pk_bf16_f32 v166, v88, v90
    v_cvt_pk_bf16_f32 v167, v92, v94
    v_cvt_pk_bf16_f32 v168, v81, v83
    v_cvt_pk_bf16_f32 v169, v85, v87
    v_cvt_pk_bf16_f32 v170, v89, v91
    v_cvt_pk_bf16_f32 v171, v93, v95
    ds_write_b128 v35, v[164:167] offset:144
    ds_write_b128 v35, v[168:171] offset:208
    v_pk_mul_f32 v[98:99], v[96:97], v[66:67] op_sel:[0,0] op_sel_hi:[0,1]
    v_pk_mul_f32 v[100:101], v[96:97], v[68:69] op_sel:[0,0] op_sel_hi:[0,1]
    v_pk_mul_f32 v[102:103], v[96:97], v[70:71] op_sel:[0,0] op_sel_hi:[0,1]
    v_pk_mul_f32 v[104:105], v[96:97], v[72:73] op_sel:[0,0] op_sel_hi:[0,1]
    v_pk_mul_f32 v[106:107], v[96:97], v[74:75] op_sel:[0,0] op_sel_hi:[0,1]
    v_pk_mul_f32 v[108:109], v[96:97], v[76:77] op_sel:[0,0] op_sel_hi:[0,1]
    v_pk_mul_f32 v[110:111], v[96:97], v[78:79] op_sel:[0,0] op_sel_hi:[0,1]
    v_pk_mul_f32 v[146:147], v[128:129], v[42:43] op_sel:[0,0] op_sel_hi:[0,1]
    v_pk_mul_f32 v[148:149], v[132:133], v[42:43] op_sel:[0,0] op_sel_hi:[0,1]
    v_pk_mul_f32 v[150:151], v[136:137], v[42:43] op_sel:[0,0] op_sel_hi:[0,1]
    v_pk_mul_f32 v[152:153], v[140:141], v[42:43] op_sel:[0,0] op_sel_hi:[0,1]
    v_pk_mul_f32 v[154:155], v[144:145], v[42:43] op_sel:[0,0] op_sel_hi:[0,1]
    v_pk_fma_f32 v[98:99], v[96:97], v[66:67], v[98:99] op_sel:[1,1,0] op_sel_hi:[1,0,1] neg_lo:[1,0,0]
    v_pk_fma_f32 v[100:101], v[96:97], v[68:69], v[100:101] op_sel:[1,1,0] op_sel_hi:[1,0,1] neg_lo:[1,0,0]
    v_pk_fma_f32 v[102:103], v[96:97], v[70:71], v[102:103] op_sel:[1,1,0] op_sel_hi:[1,0,1] neg_lo:[1,0,0]
    v_pk_fma_f32 v[104:105], v[96:97], v[72:73], v[104:105] op_sel:[1,1,0] op_sel_hi:[1,0,1] neg_lo:[1,0,0]
    v_pk_fma_f32 v[106:107], v[96:97], v[74:75], v[106:107] op_sel:[1,1,0] op_sel_hi:[1,0,1] neg_lo:[1,0,0]
    v_pk_fma_f32 v[108:109], v[96:97], v[76:77], v[108:109] op_sel:[1,1,0] op_sel_hi:[1,0,1] neg_lo:[1,0,0]
    v_pk_fma_f32 v[110:111], v[96:97], v[78:79], v[110:111] op_sel:[1,1,0] op_sel_hi:[1,0,1] neg_lo:[1,0,0]
    v_pk_fma_f32 v[146:147], v[128:129], v[42:43], v[146:147] op_sel:[1,1,0] op_sel_hi:[1,0,1] neg_lo:[1,0,0]
    v_pk_fma_f32 v[148:149], v[132:133], v[42:43], v[148:149] op_sel:[1,1,0] op_sel_hi:[1,0,1] neg_lo:[1,0,0]
    v_pk_fma_f32 v[150:151], v[136:137], v[42:43], v[150:151] op_sel:[1,1,0] op_sel_hi:[1,0,1] neg_lo:[1,0,0]
    v_pk_fma_f32 v[152:153], v[140:141], v[42:43], v[152:153] op_sel:[1,1,0] op_sel_hi:[1,0,1] neg_lo:[1,0,0]
    v_pk_fma_f32 v[154:155], v[144:145], v[42:43], v[154:155] op_sel:[1,1,0] op_sel_hi:[1,0,1] neg_lo:[1,0,0]
    v_cvt_pk_bf16_f32 v156, v96, v98
    v_cvt_pk_bf16_f32 v157, v100, v102
    v_cvt_pk_bf16_f32 v158, v104, v106
    v_cvt_pk_bf16_f32 v159, v108, v110
    v_cvt_pk_bf16_f32 v160, v97, v99
    v_cvt_pk_bf16_f32 v161, v101, v103
    v_cvt_pk_bf16_f32 v162, v105, v107
    v_cvt_pk_bf16_f32 v163, v109, v111
    ds_write_b128 v35, v[156:159] offset:160
    ds_write_b128 v35, v[160:163] offset:224
    buffer_load_dword a255, v18, s[48:51], s6 offen
    v_pk_mul_f32 v[112:113], v[96:97], v[80:81] op_sel:[0,0] op_sel_hi:[0,1]
    v_pk_mul_f32 v[114:115], v[96:97], v[82:83] op_sel:[0,0] op_sel_hi:[0,1]
    v_pk_mul_f32 v[116:117], v[96:97], v[84:85] op_sel:[0,0] op_sel_hi:[0,1]
    v_pk_mul_f32 v[118:119], v[96:97], v[86:87] op_sel:[0,0] op_sel_hi:[0,1]
    v_pk_mul_f32 v[120:121], v[96:97], v[88:89] op_sel:[0,0] op_sel_hi:[0,1]
    v_pk_mul_f32 v[122:123], v[96:97], v[90:91] op_sel:[0,0] op_sel_hi:[0,1]
    v_pk_mul_f32 v[124:125], v[96:97], v[92:93] op_sel:[0,0] op_sel_hi:[0,1]
    v_pk_mul_f32 v[126:127], v[96:97], v[94:95] op_sel:[0,0] op_sel_hi:[0,1]
    v_pk_mul_f32 v[66:67], v[146:147], v[42:43] op_sel:[0,0] op_sel_hi:[0,1]
    v_pk_mul_f32 v[68:69], v[150:151], v[42:43] op_sel:[0,0] op_sel_hi:[0,1]
    v_pk_mul_f32 v[70:71], v[154:155], v[42:43] op_sel:[0,0] op_sel_hi:[0,1]
    v_pk_fma_f32 v[112:113], v[96:97], v[80:81], v[112:113] op_sel:[1,1,0] op_sel_hi:[1,0,1] neg_lo:[1,0,0]
    v_pk_fma_f32 v[114:115], v[96:97], v[82:83], v[114:115] op_sel:[1,1,0] op_sel_hi:[1,0,1] neg_lo:[1,0,0]
    v_pk_fma_f32 v[116:117], v[96:97], v[84:85], v[116:117] op_sel:[1,1,0] op_sel_hi:[1,0,1] neg_lo:[1,0,0]
    v_pk_fma_f32 v[118:119], v[96:97], v[86:87], v[118:119] op_sel:[1,1,0] op_sel_hi:[1,0,1] neg_lo:[1,0,0]
    v_pk_fma_f32 v[120:121], v[96:97], v[88:89], v[120:121] op_sel:[1,1,0] op_sel_hi:[1,0,1] neg_lo:[1,0,0]
    v_pk_fma_f32 v[122:123], v[96:97], v[90:91], v[122:123] op_sel:[1,1,0] op_sel_hi:[1,0,1] neg_lo:[1,0,0]
    v_pk_fma_f32 v[124:125], v[96:97], v[92:93], v[124:125] op_sel:[1,1,0] op_sel_hi:[1,0,1] neg_lo:[1,0,0]
    v_pk_fma_f32 v[126:127], v[96:97], v[94:95], v[126:127] op_sel:[1,1,0] op_sel_hi:[1,0,1] neg_lo:[1,0,0]
    v_pk_fma_f32 v[66:67], v[146:147], v[42:43], v[66:67] op_sel:[1,1,0] op_sel_hi:[1,0,1] neg_lo:[1,0,0]
    v_pk_fma_f32 v[68:69], v[150:151], v[42:43], v[68:69] op_sel:[1,1,0] op_sel_hi:[1,0,1] neg_lo:[1,0,0]
    v_pk_fma_f32 v[70:71], v[154:155], v[42:43], v[70:71] op_sel:[1,1,0] op_sel_hi:[1,0,1] neg_lo:[1,0,0]
    v_cvt_pk_bf16_f32 v164, v112, v114
    v_cvt_pk_bf16_f32 v165, v116, v118
    v_cvt_pk_bf16_f32 v166, v120, v122
    v_cvt_pk_bf16_f32 v167, v124, v126
    v_cvt_pk_bf16_f32 v168, v113, v115
    v_cvt_pk_bf16_f32 v169, v117, v119
    v_cvt_pk_bf16_f32 v170, v121, v123
    v_cvt_pk_bf16_f32 v171, v125, v127
    ds_write_b128 v35, v[164:167] offset:176
    ds_write_b128 v35, v[168:171] offset:240
    s_add_u32 m0, s72, 0
    s_mov_b32 s13, 0
    buffer_load_dwordx4 v1, s[44:47], s13 offen lds
    v_pk_mul_f32 v[72:73], v[66:67], v[42:43] op_sel:[0,0] op_sel_hi:[0,1]
    v_pk_mul_f32 v[74:75], v[68:69], v[42:43] op_sel:[0,0] op_sel_hi:[0,1]
    v_pk_mul_f32 v[76:77], v[70:71], v[42:43] op_sel:[0,0] op_sel_hi:[0,1]
    v_pk_fma_f32 v[72:73], v[66:67], v[42:43], v[72:73] op_sel:[1,1,0] op_sel_hi:[1,0,1] neg_lo:[1,0,0]
    v_pk_fma_f32 v[74:75], v[68:69], v[42:43], v[74:75] op_sel:[1,1,0] op_sel_hi:[1,0,1] neg_lo:[1,0,0]
    v_pk_fma_f32 v[76:77], v[70:71], v[42:43], v[76:77] op_sel:[1,1,0] op_sel_hi:[1,0,1] neg_lo:[1,0,0]
    v_cvt_pk_bf16_f32 v156, v128, v130
    v_cvt_pk_bf16_f32 v157, v132, v134
    v_cvt_pk_bf16_f32 v158, v146, v146
    v_cvt_pk_bf16_f32 v159, v148, v150
    v_cvt_pk_bf16_f32 v160, -v129, -v131
    v_cvt_pk_bf16_f32 v161, -v133, -v135
    v_cvt_pk_bf16_f32 v162, -v147, -v147
    v_cvt_pk_bf16_f32 v163, -v149, -v151
    ds_write_b128 v36, v[156:159] offset:0
    ds_write_b128 v36, v[160:163] offset:64
    global_load_dwordx4 v[176:179], v20, s[26:27] offset:0
    global_load_dwordx4 v[180:183], v20, s[26:27] offset:16
    global_load_dwordx4 v[184:187], v20, s[26:27] offset:64
    global_load_dwordx4 v[188:191], v20, s[26:27] offset:80
    v_pk_mul_f32 v[80:81], v[72:73], v[42:43] op_sel:[0,0] op_sel_hi:[0,1]
    v_pk_mul_f32 v[82:83], v[76:77], v[42:43] op_sel:[0,0] op_sel_hi:[0,1]
    v_pk_fma_f32 v[80:81], v[72:73], v[42:43], v[80:81] op_sel:[1,1,0] op_sel_hi:[1,0,1] neg_lo:[1,0,0]
    v_pk_fma_f32 v[82:83], v[76:77], v[42:43], v[82:83] op_sel:[1,1,0] op_sel_hi:[1,0,1] neg_lo:[1,0,0]
    v_pk_mul_f32 v[84:85], v[80:81], v[42:43] op_sel:[0,0] op_sel_hi:[0,1]
    v_pk_mul_f32 v[86:87], v[82:83], v[42:43] op_sel:[0,0] op_sel_hi:[0,1]
    v_pk_fma_f32 v[84:85], v[80:81], v[42:43], v[84:85] op_sel:[1,1,0] op_sel_hi:[1,0,1] neg_lo:[1,0,0]
    v_pk_fma_f32 v[86:87], v[82:83], v[42:43], v[86:87] op_sel:[1,1,0] op_sel_hi:[1,0,1] neg_lo:[1,0,0]
    v_cvt_pk_bf16_f32 v164, v136, v138
    v_cvt_pk_bf16_f32 v165, v140, v142
    v_cvt_pk_bf16_f32 v166, v150, v150
    v_cvt_pk_bf16_f32 v167, v152, v154
    v_cvt_pk_bf16_f32 v168, -v137, -v139
    v_cvt_pk_bf16_f32 v169, -v141, -v143
    v_cvt_pk_bf16_f32 v170, -v151, -v151
    v_cvt_pk_bf16_f32 v171, -v153, -v155
    ds_write_b128 v36, v[164:167] offset:16
    ds_write_b128 v36, v[168:171] offset:80
    s_add_u32 m0, s72, 1024
    s_mov_b32 s13, 28672
    buffer_load_dwordx4 v1, s[44:47], s13 offen lds
    v_pk_mul_f32 v[88:89], v[84:85], v[42:43] op_sel:[0,0] op_sel_hi:[0,1]
    v_pk_mul_f32 v[90:91], v[86:87], v[42:43] op_sel:[0,0] op_sel_hi:[0,1]
    v_pk_fma_f32 v[88:89], v[84:85], v[42:43], v[88:89] op_sel:[1,1,0] op_sel_hi:[1,0,1] neg_lo:[1,0,0]
    v_pk_fma_f32 v[90:91], v[86:87], v[42:43], v[90:91] op_sel:[1,1,0] op_sel_hi:[1,0,1] neg_lo:[1,0,0]
    v_cvt_pk_bf16_f32 v156, v66, v68
    v_cvt_pk_bf16_f32 v157, v70, v80
    v_cvt_pk_bf16_f32 v158, v72, v74
    v_cvt_pk_bf16_f32 v159, v76, v88
    v_cvt_pk_bf16_f32 v160, -v67, -v69
    v_cvt_pk_bf16_f32 v161, -v71, -v81
    v_cvt_pk_bf16_f32 v162, -v73, -v75
    v_cvt_pk_bf16_f32 v163, -v77, -v89
    ds_write_b128 v37, v[156:159] offset:32
    ds_write_b128 v37, v[160:163] offset:96
    s_add_u32 m0, s72, 2048
    s_mov_b32 s13, 57344
    buffer_load_dwordx4 v1, s[44:47], s13 offen lds
    v_pk_mul_f32 v[92:93], v[88:89], v[42:43] op_sel:[0,0] op_sel_hi:[0,1]
    v_pk_mul_f32 v[94:95], v[90:91], v[42:43] op_sel:[0,0] op_sel_hi:[0,1]
    v_pk_fma_f32 v[92:93], v[88:89], v[42:43], v[92:93] op_sel:[1,1,0] op_sel_hi:[1,0,1] neg_lo:[1,0,0]
    v_pk_fma_f32 v[94:95], v[90:91], v[42:43], v[94:95] op_sel:[1,1,0] op_sel_hi:[1,0,1] neg_lo:[1,0,0]
    v_cvt_pk_bf16_f32 v164, v82, v84
    v_cvt_pk_bf16_f32 v165, v86, v86
    v_cvt_pk_bf16_f32 v166, v90, v92
    v_cvt_pk_bf16_f32 v167, v94, v94
    v_cvt_pk_bf16_f32 v168, -v83, -v85
    v_cvt_pk_bf16_f32 v169, -v87, -v87
    v_cvt_pk_bf16_f32 v170, -v91, -v93
    v_cvt_pk_bf16_f32 v171, -v95, -v95
    ds_write_b128 v37, v[164:167] offset:48
    ds_write_b128 v37, v[168:171] offset:112
    buffer_load_dword v57, off, s[64:67], 0 sc1
    ds_read_b64_tr_b16 a[64:65], v38 offset:0
    ds_read_b64_tr_b16 a[66:67], v38 offset:4352
    ds_read_b64_tr_b16 a[68:69], v38 offset:128
    ds_read_b64_tr_b16 a[70:71], v38 offset:4480
    ds_read_b64_tr_b16 a[72:73], v38 offset:272
    ds_read_b64_tr_b16 a[74:75], v38 offset:4624
    ds_read_b64_tr_b16 a[76:77], v38 offset:400
    ds_read_b64_tr_b16 a[78:79], v38 offset:4752
    ds_read_b64_tr_b16 a[80:81], v38 offset:544
    ds_read_b64_tr_b16 a[82:83], v38 offset:4896
    ds_read_b64_tr_b16 a[84:85], v38 offset:672
    ds_read_b64_tr_b16 a[86:87], v38 offset:5024
    s_mov_b32 s38, 0x22221111
    s_mov_b32 s39, 0x88884444
    v_mov_b32 v85, 0x3f803f80
    v_cndmask_b32 v84, 0, v85, s[38:39]
    v_mov_b32_e64 v85, v84
    v_mov_b32_e64 v86, v84
    v_mov_b32_e64 v87, v84
    s_waitcnt vmcnt(25)
    s_nop 0
    v_mfma_f32_16x16x32_bf16 v[64:67], v[84:87], v[192:195], 0
    s_waitcnt vmcnt(24)
    v_mfma_f32_16x16x32_bf16 v[80:83], v[84:87], v[220:223], 0
    s_waitcnt vmcnt(23)
    v_mfma_f32_16x16x32_bf16 v[64:67], v[84:87], v[196:199], v[64:67]
    s_waitcnt vmcnt(22)
    v_mfma_f32_16x16x32_bf16 v[80:83], v[84:87], v[224:227], v[80:83]
    s_waitcnt vmcnt(21)
    v_mfma_f32_16x16x32_bf16 v[64:67], v[84:87], v[200:203], v[64:67]
    s_waitcnt vmcnt(20)
    v_mfma_f32_16x16x32_bf16 v[80:83], v[84:87], v[228:231], v[80:83]
    s_add_u32 m0, s72, 11264
    s_mov_b32 s13, 315392
    buffer_load_dwordx4 v1, s[44:47], s13 offen lds
    s_waitcnt lgkmcnt(8)
    v_mfma_f32_32x32x16_bf16 a[208:223], a[64:67], a[68:71], a[208:223]
    ds_read_b64_tr_b16 a[88:89], v38 offset:816
    ds_read_b64_tr_b16 a[90:91], v38 offset:5168
    ds_read_b64_tr_b16 a[92:93], v38 offset:944
    ds_read_b64_tr_b16 a[94:95], v38 offset:5296
    s_add_u32 m0, s72, 3072
    s_mov_b32 s13, 86016
    buffer_load_dwordx4 v1, s[44:47], s13 offen lds
    s_waitcnt vmcnt(19)
    s_nop 0
    v_mfma_f32_16x16x32_bf16 v[64:67], v[84:87], v[204:207], v[64:67]
    s_waitcnt vmcnt(18)
    v_mfma_f32_16x16x32_bf16 v[80:83], v[84:87], v[232:235], v[80:83]
    s_waitcnt lgkmcnt(8)
    v_mfma_f32_32x32x16_bf16 a[208:223], a[72:75], a[76:79], a[208:223]
    ds_read_b64_tr_b16 a[96:97], v38 offset:1088
    ds_read_b64_tr_b16 a[98:99], v38 offset:5440
    ds_read_b64_tr_b16 a[100:101], v38 offset:1216
    ds_read_b64_tr_b16 a[102:103], v38 offset:5568
    s_add_u32 m0, s72, 4096
    s_mov_b32 s13, 114688
    buffer_load_dwordx4 v1, s[44:47], s13 offen lds
    s_waitcnt vmcnt(18)
    v_mfma_f32_16x16x32_bf16 v[64:67], v[84:87], v[208:211], v[64:67]
    s_waitcnt vmcnt(17)
    v_mfma_f32_16x16x32_bf16 v[80:83], v[84:87], v[236:239], v[80:83]
    s_waitcnt lgkmcnt(8)
    v_mfma_f32_32x32x16_bf16 a[208:223], a[80:83], a[84:87], a[208:223]
    ds_read_b64_tr_b16 a[104:105], v38 offset:1360
    ds_read_b64_tr_b16 a[106:107], v38 offset:5712
    ds_read_b64_tr_b16 a[108:109], v38 offset:1488
    ds_read_b64_tr_b16 a[110:111], v38 offset:5840
    s_add_u32 m0, s72, 5120
    s_mov_b32 s13, 143360
    buffer_load_dwordx4 v1, s[44:47], s13 offen lds
    s_waitcnt vmcnt(17)
    v_mfma_f32_16x16x32_bf16 v[64:67], v[84:87], v[212:215], v[64:67]
    s_waitcnt vmcnt(16)
    v_mfma_f32_16x16x32_bf16 v[80:83], v[84:87], v[240:243], v[80:83]
    s_waitcnt lgkmcnt(8)
    v_mfma_f32_32x32x16_bf16 a[208:223], a[88:91], a[92:95], a[208:223]
    ds_read_b64_tr_b16 a[112:113], v38 offset:1632
    ds_read_b64_tr_b16 a[114:115], v38 offset:5984
    ds_read_b64_tr_b16 a[116:117], v38 offset:1760
    ds_read_b64_tr_b16 a[118:119], v38 offset:6112
    s_add_u32 m0, s72, 6144
    s_mov_b32 s13, 172032
    buffer_load_dwordx4 v1, s[44:47], s13 offen lds
    s_waitcnt vmcnt(16)
    v_mfma_f32_16x16x32_bf16 v[64:67], v[84:87], v[216:219], v[64:67]
    s_waitcnt vmcnt(15)
    v_mfma_f32_16x16x32_bf16 v[80:83], v[84:87], v[244:247], v[80:83]
    s_waitcnt lgkmcnt(8)
    v_mfma_f32_32x32x16_bf16 a[208:223], a[96:99], a[100:103], a[208:223]
    ds_read_b64_tr_b16 a[120:121], v38 offset:1904
    ds_read_b64_tr_b16 a[122:123], v38 offset:6256
    ds_read_b64_tr_b16 a[124:125], v38 offset:2032
    ds_read_b64_tr_b16 a[126:127], v38 offset:6384
    s_add_u32 m0, s72, 7168
    s_mov_b32 s13, 200704
    buffer_load_dwordx4 v1, s[44:47], s13 offen lds
    s_waitcnt lgkmcnt(8)
    v_mfma_f32_32x32x16_bf16 a[208:223], a[104:107], a[108:111], a[208:223]
    s_add_u32 m0, s72, 8192
    s_mov_b32 s13, 229376
    buffer_load_dwordx4 v1, s[44:47], s13 offen lds
    s_mov_b32 s38, 0xffff0000
    s_mov_b32 s39, 0
    v_cndmask_b32 v64, v64, v65, s[38:39]
    v_cndmask_b32 v80, v80, v81, s[38:39]
    s_waitcnt lgkmcnt(4)
    v_mfma_f32_32x32x16_bf16 a[208:223], a[112:115], a[116:119], a[208:223]
    ds_write_b128 v22, v[192:195] offset:0
    s_add_u32 m0, s72, 9216
    s_mov_b32 s13, 258048
    buffer_load_dwordx4 v1, s[44:47], s13 offen lds
    s_mov_b32 s38, 0
    s_mov_b32 s39, 0xffff
    v_cndmask_b32 v64, v64, v66, s[38:39]
    v_cndmask_b32 v80, v80, v82, s[38:39]
    s_waitcnt lgkmcnt(1)
    v_mfma_f32_32x32x16_bf16 a[208:223], a[120:123], a[124:127], a[208:223]
    ds_write_b128 v22, v[220:223] offset:1152
    s_add_u32 m0, s72, 10240
    s_mov_b32 s13, 286720
    buffer_load_dwordx4 v1, s[44:47], s13 offen lds
    s_mov_b32 s38, 0
    s_mov_b32 s39, 0xffff0000
    v_cndmask_b32 v64, v64, v67, s[38:39]
    v_cndmask_b32 v80, v80, v83, s[38:39]
    v_mov_b32 v66, 0
    v_mov_b32_e64 v67, 0
    v_dot2c_f32_bf16 v66, v192, v192
    v_dot2c_f32_bf16 v67, v220, v220
    v_dot2c_f32_bf16 v66, v193, v193
    v_dot2c_f32_bf16 v67, v221, v221
    v_dot2c_f32_bf16 v66, v194, v194
    v_dot2c_f32_bf16 v67, v222, v222
    v_dot2c_f32_bf16 v66, v195, v195
    v_dot2c_f32_bf16 v67, v223, v223
    s_add_u32 m0, s72, 12288
    s_mov_b32 s13, 344064
    buffer_load_dwordx4 v1, s[44:47], s13 offen lds
    v_dot2c_f32_bf16 v66, v196, v196
    v_dot2c_f32_bf16 v67, v224, v224
    v_dot2c_f32_bf16 v66, v197, v197
    v_dot2c_f32_bf16 v67, v225, v225
    v_dot2c_f32_bf16 v66, v198, v198
    v_dot2c_f32_bf16 v67, v226, v226
    v_dot2c_f32_bf16 v66, v199, v199
    v_dot2c_f32_bf16 v67, v227, v227
    s_add_u32 m0, s72, 13312
    s_mov_b32 s13, 372736
    buffer_load_dwordx4 v1, s[44:47], s13 offen lds
    v_dot2c_f32_bf16 v66, v200, v200
    v_dot2c_f32_bf16 v67, v228, v228
    v_dot2c_f32_bf16 v66, v201, v201
    v_dot2c_f32_bf16 v67, v229, v229
    v_dot2c_f32_bf16 v66, v202, v202
    v_dot2c_f32_bf16 v67, v230, v230
    v_dot2c_f32_bf16 v66, v203, v203
    v_dot2c_f32_bf16 v67, v231, v231
    v_dot2c_f32_bf16 v66, v204, v204
    v_dot2c_f32_bf16 v67, v232, v232
    v_dot2c_f32_bf16 v66, v205, v205
    v_dot2c_f32_bf16 v67, v233, v233
    v_dot2c_f32_bf16 v66, v206, v206
    v_dot2c_f32_bf16 v67, v234, v234
    v_dot2c_f32_bf16 v66, v207, v207
    v_dot2c_f32_bf16 v67, v235, v235
    s_add_u32 m0, s72, 14336
    s_mov_b32 s13, 401408
    buffer_load_dwordx4 v1, s[44:47], s13 offen lds
    v_dot2c_f32_bf16 v66, v208, v208
    v_dot2c_f32_bf16 v67, v236, v236
    v_dot2c_f32_bf16 v66, v209, v209
    v_dot2c_f32_bf16 v67, v237, v237
    v_dot2c_f32_bf16 v66, v210, v210
    v_dot2c_f32_bf16 v67, v238, v238
    v_dot2c_f32_bf16 v66, v211, v211
    v_dot2c_f32_bf16 v67, v239, v239
    v_dot2c_f32_bf16 v66, v212, v212
    v_dot2c_f32_bf16 v67, v240, v240
    v_dot2c_f32_bf16 v66, v213, v213
    v_dot2c_f32_bf16 v67, v241, v241
    v_dot2c_f32_bf16 v66, v214, v214
    v_dot2c_f32_bf16 v67, v242, v242
    v_dot2c_f32_bf16 v66, v215, v215
    v_dot2c_f32_bf16 v67, v243, v243
    s_add_u32 m0, s72, 15360
    s_mov_b32 s13, 430080
    buffer_load_dwordx4 v1, s[44:47], s13 offen lds
    v_dot2c_f32_bf16 v66, v216, v216
    v_dot2c_f32_bf16 v67, v244, v244
    v_dot2c_f32_bf16 v66, v217, v217
    v_dot2c_f32_bf16 v67, v245, v245
    v_dot2c_f32_bf16 v66, v218, v218
    v_dot2c_f32_bf16 v67, v246, v246
    v_dot2c_f32_bf16 v66, v219, v219
    v_dot2c_f32_bf16 v67, v247, v247
    v_add_f32_dpp v64, v64, v64 quad_perm:[1,0,3,2] row_mask:0xf bank_mask:0xf
    v_add_f32_dpp v80, v80, v80 quad_perm:[1,0,3,2] row_mask:0xf bank_mask:0xf
    v_add_f32_dpp v66, v66, v66 quad_perm:[1,0,3,2] row_mask:0xf bank_mask:0xf
    v_add_f32_dpp v67, v67, v67 quad_perm:[1,0,3,2] row_mask:0xf bank_mask:0xf
    v_add_f32_dpp v64, v64, v64 quad_perm:[2,3,0,1] row_mask:0xf bank_mask:0xf
    v_add_f32_dpp v80, v80, v80 quad_perm:[2,3,0,1] row_mask:0xf bank_mask:0xf
    v_add_f32_dpp v66, v66, v66 quad_perm:[2,3,0,1] row_mask:0xf bank_mask:0xf
    v_add_f32_dpp v67, v67, v67 quad_perm:[2,3,0,1] row_mask:0xf bank_mask:0xf
    v_add_f32_dpp v64, v64, v64 row_half_mirror row_mask:0xf bank_mask:0xf
    v_add_f32_dpp v80, v80, v80 row_half_mirror row_mask:0xf bank_mask:0xf
    v_add_f32_dpp v66, v66, v66 row_half_mirror row_mask:0xf bank_mask:0xf
    v_add_f32_dpp v67, v67, v67 row_half_mirror row_mask:0xf bank_mask:0xf
    v_mul_f32 v64, 0x3b124925, v64
    v_mul_f32 v80, 0x3b124925, v80
    v_mul_f32 v66, 0x3b124925, v66
    v_mul_f32 v67, 0x3b124925, v67
    v_fma_f32 v66, -v64, v64, v66
    v_fma_f32 v67, -v80, v80, v67
    v_max_f32_e64 v66, 0, v66
    v_max_f32_e64 v67, 0, v67
    v_cvt_pk_bf16_f32 v76, v64, v80
    v_lshlrev_b32_e64 v68, 16, v76
    v_and_b32_e64 v70, s3, v76
    v_cvt_pk_bf16_f32 v76, v66, v67
    v_lshlrev_b32_e64 v69, 16, v76
    v_and_b32_e64 v71, s3, v76
    v_add_f32 v69, 0x3727c5ac, v69
    v_add_f32 v71, 0x3727c5ac, v71
    v_cvt_pk_bf16_f32 v76, v69, v71
    v_lshlrev_b32_e64 v69, 16, v76
    v_and_b32_e64 v71, s3, v76
    v_sqrt_f32_e64 v69, v69
    v_sqrt_f32 v71, v71
    s_nop 0
    v_cvt_pk_bf16_f32 v76, v69, v71
    v_lshlrev_b32_e64 v69, 16, v76
    v_and_b32_e64 v71, s3, v76
    v_rcp_f32_e64 v69, v69
    v_rcp_f32_e64 v71, v71
    v_sub_f32_e64 v64, v64, v68
    v_mul_f32_e64 v66, v66, v69
    v_sub_f32_e64 v80, v80, v70
    v_mul_f32_e64 v67, v67, v71
    v_mul_f32_e64 v64, v64, v69
    v_mul_f32_e64 v66, v66, v69
    v_mul_f32_e64 v80, v80, v71
    v_mul_f32_e64 v67, v67, v71
    v_cvt_pk_bf16_f32 v76, v64, v80
    v_lshlrev_b32_e64 v64, 16, v76
    v_and_b32_e64 v80, s3, v76
    v_cvt_pk_bf16_f32 v76, v66, v67
    v_lshlrev_b32_e64 v73, 16, v76
    v_and_b32_e64 v75, s3, v76
    v_add_f32 v73, 0x3727c5ac, v73
    v_add_f32 v75, 0x3727c5ac, v75
    v_cvt_pk_bf16_f32 v76, v73, v75
    v_lshlrev_b32_e64 v73, 16, v76
    v_and_b32_e64 v75, s3, v76
    v_sqrt_f32_e64 v73, v73
    v_sqrt_f32 v75, v75
    s_nop 0
    v_cvt_pk_bf16_f32 v76, v73, v75
    v_lshlrev_b32_e64 v73, 16, v76
    v_and_b32_e64 v75, s3, v76
    v_rcp_f32_e64 v73, v73
    v_rcp_f32_e64 v75, v75
    v_mul_f32_e64 v72, v69, v73
    v_mul_f32_e64 v64, v64, v73
    v_mul_f32_e64 v74, v71, v75
    v_mul_f32_e64 v80, v80, v75
    v_fma_f32 v73, -v68, v72, -v64
    v_fma_f32 v75, -v70, v74, -v80
    v_lshlrev_b32_e64 v76, 16, v192
    v_and_b32_e64 v77, s3, v192
    v_lshlrev_b32_e64 v78, 16, v193
    v_and_b32_e64 v79, s3, v193
    v_lshlrev_b32_e64 v80, 16, v194
    v_and_b32_e64 v81, s3, v194
    v_lshlrev_b32_e64 v82, 16, v195
    v_and_b32_e64 v83, s3, v195
    v_pk_add_f32 v[76:77], v[76:77], v[68:69] op_sel_hi:[1,0] neg_lo:[0,1] neg_hi:[0,1]
    v_pk_add_f32 v[78:79], v[78:79], v[68:69] op_sel_hi:[1,0] neg_lo:[0,1] neg_hi:[0,1]
    v_pk_add_f32 v[80:81], v[80:81], v[68:69] op_sel_hi:[1,0] neg_lo:[0,1] neg_hi:[0,1]
    v_pk_add_f32 v[82:83], v[82:83], v[68:69] op_sel_hi:[1,0] neg_lo:[0,1] neg_hi:[0,1]
    v_cvt_pk_bf16_f32 v96, v76, v77
    v_cvt_pk_bf16_f32 v97, v78, v79
    v_cvt_pk_bf16_f32 v98, v80, v81
    v_cvt_pk_bf16_f32 v99, v82, v83
    v_lshlrev_b32_e64 v76, 16, v96
    v_and_b32_e64 v77, s3, v96
    v_lshlrev_b32_e64 v78, 16, v97
    v_and_b32_e64 v79, s3, v97
    v_lshlrev_b32_e64 v80, 16, v98
    v_and_b32_e64 v81, s3, v98
    v_lshlrev_b32_e64 v82, 16, v99
    v_and_b32_e64 v83, s3, v99
    v_pk_mul_f32 v[76:77], v[76:77], v[68:69] op_sel:[0,1] op_sel_hi:[1,1]
    v_pk_mul_f32 v[78:79], v[78:79], v[68:69] op_sel:[0,1] op_sel_hi:[1,1]
    v_pk_mul_f32 v[80:81], v[80:81], v[68:69] op_sel:[0,1] op_sel_hi:[1,1]
    v_pk_mul_f32 v[82:83], v[82:83], v[68:69] op_sel:[0,1] op_sel_hi:[1,1]
    v_cvt_pk_bf16_f32 v96, v76, v77
    v_cvt_pk_bf16_f32 v97, v78, v79
    v_cvt_pk_bf16_f32 v98, v80, v81
    v_cvt_pk_bf16_f32 v99, v82, v83
    ds_write_b128 v23, v[96:99] offset:0
    s_add_u32 m0, s72, 16384
    s_mov_b32 s13, 458752
    buffer_load_dwordx4 v1, s[44:47], s13 offen lds
    v_lshlrev_b32_e64 v76, 16, v220
    v_and_b32_e64 v77, s3, v220
    v_lshlrev_b32_e64 v78, 16, v221
    v_and_b32_e64 v79, s3, v221
    v_lshlrev_b32_e64 v80, 16, v222
    v_and_b32_e64 v81, s3, v222
    v_lshlrev_b32_e64 v82, 16, v223
    v_and_b32_e64 v83, s3, v223
    v_pk_add_f32 v[76:77], v[76:77], v[70:71] op_sel_hi:[1,0] neg_lo:[0,1] neg_hi:[0,1]
    v_pk_add_f32 v[78:79], v[78:79], v[70:71] op_sel_hi:[1,0] neg_lo:[0,1] neg_hi:[0,1]
    v_pk_add_f32 v[80:81], v[80:81], v[70:71] op_sel_hi:[1,0] neg_lo:[0,1] neg_hi:[0,1]
    v_pk_add_f32 v[82:83], v[82:83], v[70:71] op_sel_hi:[1,0] neg_lo:[0,1] neg_hi:[0,1]
    v_cvt_pk_bf16_f32 v100, v76, v77
    v_cvt_pk_bf16_f32 v101, v78, v79
    v_cvt_pk_bf16_f32 v102, v80, v81
    v_cvt_pk_bf16_f32 v103, v82, v83
    v_lshlrev_b32_e64 v76, 16, v100
    v_and_b32_e64 v77, s3, v100
    v_lshlrev_b32_e64 v78, 16, v101
    v_and_b32_e64 v79, s3, v101
    v_lshlrev_b32_e64 v80, 16, v102
    v_and_b32_e64 v81, s3, v102
    v_lshlrev_b32_e64 v82, 16, v103
    v_and_b32_e64 v83, s3, v103
    v_pk_mul_f32 v[76:77], v[76:77], v[70:71] op_sel:[0,1] op_sel_hi:[1,1]
    v_pk_mul_f32 v[78:79], v[78:79], v[70:71] op_sel:[0,1] op_sel_hi:[1,1]
    v_pk_mul_f32 v[80:81], v[80:81], v[70:71] op_sel:[0,1] op_sel_hi:[1,1]
    v_pk_mul_f32 v[82:83], v[82:83], v[70:71] op_sel:[0,1] op_sel_hi:[1,1]
    v_cvt_pk_bf16_f32 v100, v76, v77
    v_cvt_pk_bf16_f32 v101, v78, v79
    v_cvt_pk_bf16_f32 v102, v80, v81
    v_cvt_pk_bf16_f32 v103, v82, v83
    ds_write_b128 v23, v[100:103] offset:1152
    ds_read_b64_tr_b16 v[112:113], v26 offset:0
    ds_read_b64_tr_b16 v[114:115], v26 offset:576
    ds_read_b64_tr_b16 v[116:117], v26 offset:64
    ds_read_b64_tr_b16 v[118:119], v26 offset:640
    s_add_u32 m0, s72, 17408
    s_mov_b32 s13, 487424
    buffer_load_dwordx4 v1, s[44:47], s13 offen lds
    s_add_u32 s73, s5, 131072
    v_add_u32_e64 v104, s76, v21
    v_lshlrev_b32_e64 v76, 16, v192
    v_and_b32_e64 v77, s3, v192
    v_lshlrev_b32_e64 v78, 16, v193
    v_and_b32_e64 v79, s3, v193
    v_lshlrev_b32_e64 v80, 16, v194
    v_and_b32_e64 v81, s3, v194
    v_lshlrev_b32_e64 v82, 16, v195
    v_and_b32_e64 v83, s3, v195
    v_pk_fma_f32 v[76:77], v[76:77], v[72:73], v[72:73] op_sel:[0,0,1] op_sel_hi:[1,0,1]
    v_pk_fma_f32 v[78:79], v[78:79], v[72:73], v[72:73] op_sel:[0,0,1] op_sel_hi:[1,0,1]
    v_pk_fma_f32 v[80:81], v[80:81], v[72:73], v[72:73] op_sel:[0,0,1] op_sel_hi:[1,0,1]
    v_pk_fma_f32 v[82:83], v[82:83], v[72:73], v[72:73] op_sel:[0,0,1] op_sel_hi:[1,0,1]
    v_cvt_pk_bf16_f32 v192, v76, v77
    v_cvt_pk_bf16_f32 v193, v78, v79
    v_cvt_pk_bf16_f32 v194, v80, v81
    v_cvt_pk_bf16_f32 v195, v82, v83
    ds_write_b128 v104, v[192:195] offset:0
    s_waitcnt lgkmcnt(3)
    buffer_store_dwordx4 v[112:115], v27, s[52:55], s5 offen sc1
    v_lshlrev_b32 v84, 16, v220
    v_and_b32_e64 v85, s3, v220
    v_lshlrev_b32_e64 v86, 16, v221
    v_and_b32_e64 v87, s3, v221
    v_lshlrev_b32_e64 v88, 16, v222
    v_and_b32_e64 v89, s3, v222
    v_lshlrev_b32_e64 v90, 16, v223
    v_and_b32_e64 v91, s3, v223
    v_pk_fma_f32 v[84:85], v[84:85], v[74:75], v[74:75] op_sel:[0,0,1] op_sel_hi:[1,0,1]
    v_pk_fma_f32 v[86:87], v[86:87], v[74:75], v[74:75] op_sel:[0,0,1] op_sel_hi:[1,0,1]
    v_pk_fma_f32 v[88:89], v[88:89], v[74:75], v[74:75] op_sel:[0,0,1] op_sel_hi:[1,0,1]
    v_pk_fma_f32 v[90:91], v[90:91], v[74:75], v[74:75] op_sel:[0,0,1] op_sel_hi:[1,0,1]
    v_cvt_pk_bf16_f32 v220, v84, v85
    v_cvt_pk_bf16_f32 v221, v86, v87
    v_cvt_pk_bf16_f32 v222, v88, v89
    v_cvt_pk_bf16_f32 v223, v90, v91
    ds_write_b128 v104, v[220:223] offset:7296
    s_waitcnt lgkmcnt(2)
    buffer_store_dwordx4 v[116:119], v27, s[52:55], s73 offen sc1
    v_add_u32 v105, s77, v21
    v_lshlrev_b32_e64 v76, 16, v196
    v_and_b32_e64 v77, s3, v196
    v_lshlrev_b32_e64 v78, 16, v197
    v_and_b32_e64 v79, s3, v197
    v_lshlrev_b32_e64 v80, 16, v198
    v_and_b32_e64 v81, s3, v198
    v_lshlrev_b32_e64 v82, 16, v199
    v_and_b32_e64 v83, s3, v199
    v_pk_fma_f32 v[76:77], v[76:77], v[72:73], v[72:73] op_sel:[0,0,1] op_sel_hi:[1,0,1]
    v_pk_fma_f32 v[78:79], v[78:79], v[72:73], v[72:73] op_sel:[0,0,1] op_sel_hi:[1,0,1]
    v_pk_fma_f32 v[80:81], v[80:81], v[72:73], v[72:73] op_sel:[0,0,1] op_sel_hi:[1,0,1]
    v_pk_fma_f32 v[82:83], v[82:83], v[72:73], v[72:73] op_sel:[0,0,1] op_sel_hi:[1,0,1]
    v_cvt_pk_bf16_f32 v196, v76, v77
    v_cvt_pk_bf16_f32 v197, v78, v79
    v_cvt_pk_bf16_f32 v198, v80, v81
    v_cvt_pk_bf16_f32 v199, v82, v83
    ds_write_b128 v105, v[196:199] offset:0
    v_lshlrev_b32_e64 v84, 16, v224
    v_and_b32_e64 v85, s3, v224
    v_lshlrev_b32_e64 v86, 16, v225
    v_and_b32_e64 v87, s3, v225
    v_lshlrev_b32_e64 v88, 16, v226
    v_and_b32_e64 v89, s3, v226
    v_lshlrev_b32_e64 v90, 16, v227
    v_and_b32_e64 v91, s3, v227
    v_pk_fma_f32 v[84:85], v[84:85], v[74:75], v[74:75] op_sel:[0,0,1] op_sel_hi:[1,0,1]
    v_pk_fma_f32 v[86:87], v[86:87], v[74:75], v[74:75] op_sel:[0,0,1] op_sel_hi:[1,0,1]
    v_pk_fma_f32 v[88:89], v[88:89], v[74:75], v[74:75] op_sel:[0,0,1] op_sel_hi:[1,0,1]
    v_pk_fma_f32 v[90:91], v[90:91], v[74:75], v[74:75] op_sel:[0,0,1] op_sel_hi:[1,0,1]
    v_cvt_pk_bf16_f32 v224, v84, v85
    v_cvt_pk_bf16_f32 v225, v86, v87
    v_cvt_pk_bf16_f32 v226, v88, v89
    v_cvt_pk_bf16_f32 v227, v90, v91
    ds_write_b128 v105, v[224:227] offset:7296
    v_add_u32_e64 v106, s78, v21
    v_lshlrev_b32_e64 v76, 16, v200
    v_and_b32_e64 v77, s3, v200
    v_lshlrev_b32_e64 v78, 16, v201
    v_and_b32_e64 v79, s3, v201
    v_lshlrev_b32_e64 v80, 16, v202
    v_and_b32_e64 v81, s3, v202
    v_lshlrev_b32_e64 v82, 16, v203
    v_and_b32_e64 v83, s3, v203
    v_pk_fma_f32 v[76:77], v[76:77], v[72:73], v[72:73] op_sel:[0,0,1] op_sel_hi:[1,0,1]
    v_pk_fma_f32 v[78:79], v[78:79], v[72:73], v[72:73] op_sel:[0,0,1] op_sel_hi:[1,0,1]
    v_pk_fma_f32 v[80:81], v[80:81], v[72:73], v[72:73] op_sel:[0,0,1] op_sel_hi:[1,0,1]
    v_pk_fma_f32 v[82:83], v[82:83], v[72:73], v[72:73] op_sel:[0,0,1] op_sel_hi:[1,0,1]
    v_cvt_pk_bf16_f32 v200, v76, v77
    v_cvt_pk_bf16_f32 v201, v78, v79
    v_cvt_pk_bf16_f32 v202, v80, v81
    v_cvt_pk_bf16_f32 v203, v82, v83
    ds_write_b128 v106, v[200:203] offset:0
    v_lshlrev_b32_e64 v84, 16, v228
    v_and_b32_e64 v85, s3, v228
    v_lshlrev_b32_e64 v86, 16, v229
    v_and_b32_e64 v87, s3, v229
    v_lshlrev_b32_e64 v88, 16, v230
    v_and_b32_e64 v89, s3, v230
    v_lshlrev_b32_e64 v90, 16, v231
    v_and_b32_e64 v91, s3, v231
    v_pk_fma_f32 v[84:85], v[84:85], v[74:75], v[74:75] op_sel:[0,0,1] op_sel_hi:[1,0,1]
    v_pk_fma_f32 v[86:87], v[86:87], v[74:75], v[74:75] op_sel:[0,0,1] op_sel_hi:[1,0,1]
    v_pk_fma_f32 v[88:89], v[88:89], v[74:75], v[74:75] op_sel:[0,0,1] op_sel_hi:[1,0,1]
    v_pk_fma_f32 v[90:91], v[90:91], v[74:75], v[74:75] op_sel:[0,0,1] op_sel_hi:[1,0,1]
    v_cvt_pk_bf16_f32 v228, v84, v85
    v_cvt_pk_bf16_f32 v229, v86, v87
    v_cvt_pk_bf16_f32 v230, v88, v89
    v_cvt_pk_bf16_f32 v231, v90, v91
    ds_write_b128 v106, v[228:231] offset:7296
    v_add_u32_e64 v107, s79, v21
    v_lshlrev_b32_e64 v76, 16, v204
    v_and_b32_e64 v77, s3, v204
    v_lshlrev_b32_e64 v78, 16, v205
    v_and_b32_e64 v79, s3, v205
    v_lshlrev_b32_e64 v80, 16, v206
    v_and_b32_e64 v81, s3, v206
    v_lshlrev_b32_e64 v82, 16, v207
    v_and_b32_e64 v83, s3, v207
    v_pk_fma_f32 v[76:77], v[76:77], v[72:73], v[72:73] op_sel:[0,0,1] op_sel_hi:[1,0,1]
    v_pk_fma_f32 v[78:79], v[78:79], v[72:73], v[72:73] op_sel:[0,0,1] op_sel_hi:[1,0,1]
    v_pk_fma_f32 v[80:81], v[80:81], v[72:73], v[72:73] op_sel:[0,0,1] op_sel_hi:[1,0,1]
    v_pk_fma_f32 v[82:83], v[82:83], v[72:73], v[72:73] op_sel:[0,0,1] op_sel_hi:[1,0,1]
    v_cvt_pk_bf16_f32 v204, v76, v77
    v_cvt_pk_bf16_f32 v205, v78, v79
    v_cvt_pk_bf16_f32 v206, v80, v81
    v_cvt_pk_bf16_f32 v207, v82, v83
    ds_write_b128 v107, v[204:207] offset:0
    v_lshlrev_b32_e64 v84, 16, v232
    v_and_b32_e64 v85, s3, v232
    v_lshlrev_b32_e64 v86, 16, v233
    v_and_b32_e64 v87, s3, v233
    v_lshlrev_b32_e64 v88, 16, v234
    v_and_b32_e64 v89, s3, v234
    v_lshlrev_b32_e64 v90, 16, v235
    v_and_b32_e64 v91, s3, v235
    v_pk_fma_f32 v[84:85], v[84:85], v[74:75], v[74:75] op_sel:[0,0,1] op_sel_hi:[1,0,1]
    v_pk_fma_f32 v[86:87], v[86:87], v[74:75], v[74:75] op_sel:[0,0,1] op_sel_hi:[1,0,1]
    v_pk_fma_f32 v[88:89], v[88:89], v[74:75], v[74:75] op_sel:[0,0,1] op_sel_hi:[1,0,1]
    v_pk_fma_f32 v[90:91], v[90:91], v[74:75], v[74:75] op_sel:[0,0,1] op_sel_hi:[1,0,1]
    v_cvt_pk_bf16_f32 v232, v84, v85
    v_cvt_pk_bf16_f32 v233, v86, v87
    v_cvt_pk_bf16_f32 v234, v88, v89
    v_cvt_pk_bf16_f32 v235, v90, v91
    ds_write_b128 v107, v[232:235] offset:7296
    v_add_u32_e64 v108, s80, v21
    v_lshlrev_b32_e64 v76, 16, v208
    v_and_b32_e64 v77, s3, v208
    v_lshlrev_b32_e64 v78, 16, v209
    v_and_b32_e64 v79, s3, v209
    v_lshlrev_b32_e64 v80, 16, v210
    v_and_b32_e64 v81, s3, v210
    v_lshlrev_b32_e64 v82, 16, v211
    v_and_b32_e64 v83, s3, v211
    v_pk_fma_f32 v[76:77], v[76:77], v[72:73], v[72:73] op_sel:[0,0,1] op_sel_hi:[1,0,1]
    v_pk_fma_f32 v[78:79], v[78:79], v[72:73], v[72:73] op_sel:[0,0,1] op_sel_hi:[1,0,1]
    v_pk_fma_f32 v[80:81], v[80:81], v[72:73], v[72:73] op_sel:[0,0,1] op_sel_hi:[1,0,1]
    v_pk_fma_f32 v[82:83], v[82:83], v[72:73], v[72:73] op_sel:[0,0,1] op_sel_hi:[1,0,1]
    v_cvt_pk_bf16_f32 v208, v76, v77
    v_cvt_pk_bf16_f32 v209, v78, v79
    v_cvt_pk_bf16_f32 v210, v80, v81
    v_cvt_pk_bf16_f32 v211, v82, v83
    ds_write_b128 v108, v[208:211] offset:0
    v_lshlrev_b32_e64 v84, 16, v236
    v_and_b32_e64 v85, s3, v236
    v_lshlrev_b32_e64 v86, 16, v237
    v_and_b32_e64 v87, s3, v237
    v_lshlrev_b32_e64 v88, 16, v238
    v_and_b32_e64 v89, s3, v238
    v_lshlrev_b32_e64 v90, 16, v239
    v_and_b32_e64 v91, s3, v239
    v_pk_fma_f32 v[84:85], v[84:85], v[74:75], v[74:75] op_sel:[0,0,1] op_sel_hi:[1,0,1]
    v_pk_fma_f32 v[86:87], v[86:87], v[74:75], v[74:75] op_sel:[0,0,1] op_sel_hi:[1,0,1]
    v_pk_fma_f32 v[88:89], v[88:89], v[74:75], v[74:75] op_sel:[0,0,1] op_sel_hi:[1,0,1]
    v_pk_fma_f32 v[90:91], v[90:91], v[74:75], v[74:75] op_sel:[0,0,1] op_sel_hi:[1,0,1]
    v_cvt_pk_bf16_f32 v236, v84, v85
    v_cvt_pk_bf16_f32 v237, v86, v87
    v_cvt_pk_bf16_f32 v238, v88, v89
    v_cvt_pk_bf16_f32 v239, v90, v91
    ds_write_b128 v108, v[236:239] offset:7296
    v_add_u32_e64 v109, s81, v21
    v_lshlrev_b32_e64 v76, 16, v212
    v_and_b32_e64 v77, s3, v212
    v_lshlrev_b32_e64 v78, 16, v213
    v_and_b32_e64 v79, s3, v213
    v_lshlrev_b32_e64 v80, 16, v214
    v_and_b32_e64 v81, s3, v214
    v_lshlrev_b32_e64 v82, 16, v215
    v_and_b32_e64 v83, s3, v215
    v_pk_fma_f32 v[76:77], v[76:77], v[72:73], v[72:73] op_sel:[0,0,1] op_sel_hi:[1,0,1]
    v_pk_fma_f32 v[78:79], v[78:79], v[72:73], v[72:73] op_sel:[0,0,1] op_sel_hi:[1,0,1]
    v_pk_fma_f32 v[80:81], v[80:81], v[72:73], v[72:73] op_sel:[0,0,1] op_sel_hi:[1,0,1]
    v_pk_fma_f32 v[82:83], v[82:83], v[72:73], v[72:73] op_sel:[0,0,1] op_sel_hi:[1,0,1]
    v_cvt_pk_bf16_f32 v212, v76, v77
    v_cvt_pk_bf16_f32 v213, v78, v79
    v_cvt_pk_bf16_f32 v214, v80, v81
    v_cvt_pk_bf16_f32 v215, v82, v83
    ds_write_b128 v109, v[212:215] offset:0
    v_lshlrev_b32_e64 v84, 16, v240
    v_and_b32_e64 v85, s3, v240
    v_lshlrev_b32_e64 v86, 16, v241
    v_and_b32_e64 v87, s3, v241
    v_lshlrev_b32_e64 v88, 16, v242
    v_and_b32_e64 v89, s3, v242
    v_lshlrev_b32_e64 v90, 16, v243
    v_and_b32_e64 v91, s3, v243
    v_pk_fma_f32 v[84:85], v[84:85], v[74:75], v[74:75] op_sel:[0,0,1] op_sel_hi:[1,0,1]
    v_pk_fma_f32 v[86:87], v[86:87], v[74:75], v[74:75] op_sel:[0,0,1] op_sel_hi:[1,0,1]
    v_pk_fma_f32 v[88:89], v[88:89], v[74:75], v[74:75] op_sel:[0,0,1] op_sel_hi:[1,0,1]
    v_pk_fma_f32 v[90:91], v[90:91], v[74:75], v[74:75] op_sel:[0,0,1] op_sel_hi:[1,0,1]
    v_cvt_pk_bf16_f32 v240, v84, v85
    v_cvt_pk_bf16_f32 v241, v86, v87
    v_cvt_pk_bf16_f32 v242, v88, v89
    v_cvt_pk_bf16_f32 v243, v90, v91
    ds_write_b128 v109, v[240:243] offset:7296
    v_add_u32_e64 v110, s82, v21
    v_lshlrev_b32_e64 v76, 16, v216
    v_and_b32_e64 v77, s3, v216
    v_lshlrev_b32_e64 v78, 16, v217
    v_and_b32_e64 v79, s3, v217
    v_lshlrev_b32_e64 v80, 16, v218
    v_and_b32_e64 v81, s3, v218
    v_lshlrev_b32_e64 v82, 16, v219
    v_and_b32_e64 v83, s3, v219
    v_pk_fma_f32 v[76:77], v[76:77], v[72:73], v[72:73] op_sel:[0,0,1] op_sel_hi:[1,0,1]
    v_pk_fma_f32 v[78:79], v[78:79], v[72:73], v[72:73] op_sel:[0,0,1] op_sel_hi:[1,0,1]
    v_pk_fma_f32 v[80:81], v[80:81], v[72:73], v[72:73] op_sel:[0,0,1] op_sel_hi:[1,0,1]
    v_pk_fma_f32 v[82:83], v[82:83], v[72:73], v[72:73] op_sel:[0,0,1] op_sel_hi:[1,0,1]
    v_cvt_pk_bf16_f32 v216, v76, v77
    v_cvt_pk_bf16_f32 v217, v78, v79
    v_cvt_pk_bf16_f32 v218, v80, v81
    v_cvt_pk_bf16_f32 v219, v82, v83
    ds_write_b128 v110, v[216:219] offset:0
    v_lshlrev_b32_e64 v84, 16, v244
    v_and_b32_e64 v85, s3, v244
    v_lshlrev_b32_e64 v86, 16, v245
    v_and_b32_e64 v87, s3, v245
    v_lshlrev_b32_e64 v88, 16, v246
    v_and_b32_e64 v89, s3, v246
    v_lshlrev_b32_e64 v90, 16, v247
    v_and_b32_e64 v91, s3, v247
    v_pk_fma_f32 v[84:85], v[84:85], v[74:75], v[74:75] op_sel:[0,0,1] op_sel_hi:[1,0,1]
    v_pk_fma_f32 v[86:87], v[86:87], v[74:75], v[74:75] op_sel:[0,0,1] op_sel_hi:[1,0,1]
    v_pk_fma_f32 v[88:89], v[88:89], v[74:75], v[74:75] op_sel:[0,0,1] op_sel_hi:[1,0,1]
    v_pk_fma_f32 v[90:91], v[90:91], v[74:75], v[74:75] op_sel:[0,0,1] op_sel_hi:[1,0,1]
    v_cvt_pk_bf16_f32 v244, v84, v85
    v_cvt_pk_bf16_f32 v245, v86, v87
    v_cvt_pk_bf16_f32 v246, v88, v89
    v_cvt_pk_bf16_f32 v247, v90, v91
    ds_write_b128 v110, v[244:247] offset:7296
    ds_write_b128 v28, a[216:219] offset:0
    ds_write_b128 v28, a[220:223] offset:1024
    s_waitcnt vmcnt(23)
    v_lshlrev_b32 v144, 16, v176
    v_and_b32_e64 v145, s3, v176
    v_lshlrev_b32_e64 v146, 16, v177
    v_and_b32_e64 v147, s3, v177
    v_lshlrev_b32_e64 v148, 16, v178
    v_and_b32_e64 v149, s3, v178
    v_lshlrev_b32_e64 v150, 16, v179
    v_and_b32 v151, s3, v179
    s_waitcnt vmcnt(22)
    v_lshlrev_b32_e64 v152, 16, v180
    v_and_b32_e64 v153, s3, v180
    v_lshlrev_b32_e64 v154, 16, v181
    v_and_b32_e64 v155, s3, v181
    v_lshlrev_b32_e64 v156, 16, v182
    v_and_b32_e64 v157, s3, v182
    v_lshlrev_b32_e64 v158, 16, v183
    v_and_b32 v159, s3, v183
    s_waitcnt vmcnt(21)
    v_lshlrev_b32_e64 v160, 16, v184
    v_and_b32_e64 v161, s3, v184
    v_lshlrev_b32_e64 v162, 16, v185
    v_and_b32_e64 v163, s3, v185
    v_lshlrev_b32_e64 v164, 16, v186
    v_and_b32_e64 v165, s3, v186
    v_lshlrev_b32_e64 v166, 16, v187
    v_and_b32 v167, s3, v187
    s_waitcnt vmcnt(20)
    v_lshlrev_b32_e64 v168, 16, v188
    v_and_b32_e64 v169, s3, v188
    v_lshlrev_b32_e64 v170, 16, v189
    v_and_b32_e64 v171, s3, v189
    v_lshlrev_b32_e64 v172, 16, v190
    v_and_b32_e64 v173, s3, v190
    v_lshlrev_b32_e64 v174, 16, v191
    v_and_b32 v175, s3, v191
    s_waitcnt vmcnt(17)
    v_readfirstlane_b32 s71, v57
    s_nop 0
    s_cmp_eq_u32 s71, 0
    s_nop 2
    s_cbranch_scc0 P1_ok
    s_mov_b32 s99, 0x40000
P1_lp:
    buffer_load_dword v57, off, s[64:67], 0 sc1
    s_waitcnt vmcnt(0)
    s_sub_u32 s99, s99, 1
    s_cbranch_scc1 P1_ok
    v_readfirstlane_b32 s71, v57
    s_nop 0
    s_cmp_eq_u32 s71, 0
    s_nop 2
    s_cbranch_scc1 P1_lp
P1_ok:
    s_waitcnt vmcnt(0)
    s_waitcnt lgkmcnt(0)
    s_barrier
    ds_read_b64_tr_b16 a[0:1], v3 offset:0
    ds_read_b64_tr_b16 a[2:3], v3 offset:512
    ds_read_b128 a[8:11], v5 offset:0
    ds_read_b64_tr_b16 a[4:5], v4 offset:0
    ds_read_b64_tr_b16 a[6:7], v4 offset:512
    ds_read_b128 a[12:15], v6 offset:0
    ds_read_b64_tr_b16 a[16:17], v3 offset:2048
    ds_read_b64_tr_b16 a[18:19], v3 offset:2560
    ds_read_b128 a[24:27], v5 offset:32
    ds_read_b64_tr_b16 a[20:21], v4 offset:2048
    ds_read_b64_tr_b16 a[22:23], v4 offset:2560
    ds_read_b128 a[28:31], v6 offset:32
    s_waitcnt lgkmcnt(9)
    s_nop 0
    v_mfma_f32_32x32x16_bf16 v[64:79], a[0:3], a[8:11], v[144:159]
    ds_read_b64_tr_b16 a[32:33], v3 offset:4096
    ds_read_b64_tr_b16 a[34:35], v3 offset:4608
    ds_read_b128 a[40:43], v5 offset:64
    v_mov_b32 v62, s71
    s_mov_b64 exec, 1
    buffer_store_dword v62, off, s[52:55], s4 offset:0 sc1
    s_mov_b64 exec, -1
    s_waitcnt lgkmcnt(10)
    v_mfma_f32_32x32x16_bf16 v[80:95], a[4:7], a[8:11], v[160:175]
    ds_read_b64_tr_b16 a[36:37], v4 offset:4096
    ds_read_b64_tr_b16 a[38:39], v4 offset:4608
    ds_read_b128 a[44:47], v6 offset:64
    ds_read_b128 v[128:131], v29
    ds_read_b128 v[132:135], v29 offset:1024
    s_waitcnt lgkmcnt(14)
    v_mfma_f32_32x32x16_bf16 v[96:111], a[0:3], a[12:15], v[144:159]
    s_add_u32 m0, s72, 0
    s_mov_b32 s13, 516096
    buffer_load_dwordx4 v1, s[44:47], s13 offen lds
    s_mov_b32 s56, s32
    s_mov_b32 s57, s33
    s_mov_b32 s58, 1835008
    s_mov_b32 s59, 0x00020000
    v_mfma_f32_32x32x16_bf16 v[112:127], a[4:7], a[12:15], v[160:175]
    s_add_u32 m0, s72, 1024
    s_mov_b32 s13, 544768
    buffer_load_dwordx4 v1, s[44:47], s13 offen lds
    s_mul_i32 s38, s70, 57344
    s_add_u32 s38, s38, s14
    v_add_u32 v2, s38, v2
    s_mul_i32 s39, s69, 28
    s_waitcnt lgkmcnt(11)
    v_mfma_f32_32x32x16_bf16 v[64:79], a[16:19], a[24:27], v[64:79]
    ds_read_b64_tr_b16 a[0:1], v3 offset:6144
    ds_read_b64_tr_b16 a[2:3], v3 offset:6656
    ds_read_b128 a[8:11], v5 offset:96
    s_add_u32 s39, s39, s70
    s_lshl_b32 s39, s39, 13
    s_add_u32 s39, s39, 4194304
    s_waitcnt lgkmcnt(12)
    v_mfma_f32_32x32x16_bf16 v[80:95], a[20:23], a[24:27], v[80:95]
    ds_read_b64_tr_b16 a[4:5], v4 offset:6144
    ds_read_b64_tr_b16 a[6:7], v4 offset:6656
    ds_read_b128 a[12:15], v6 offset:96
    s_add_u32 s38, s68, 0
    s_cmp_ge_u32 s38, 7
    s_cselect_b32 s92, 7, 0
    s_sub_u32 s38, s38, s92
    s_waitcnt lgkmcnt(14)
    v_mfma_f32_32x32x16_bf16 v[96:111], a[16:19], a[28:31], v[96:111]
    s_add_u32 m0, s72, 2048
    s_mov_b32 s13, 573440
    buffer_load_dwordx4 v1, s[44:47], s13 offen lds
    s_mul_i32 s76, s38, 229376
    s_lshl_b32 s38, s38, 15
    s_add_u32 s83, s38, s39
    v_mfma_f32_32x32x16_bf16 v[112:127], a[20:23], a[28:31], v[112:127]
    s_add_u32 m0, s72, 3072
    s_mov_b32 s13, 602112
    buffer_load_dwordx4 v1, s[44:47], s13 offen lds
    s_add_u32 s38, s68, 1
    s_cmp_ge_u32 s38, 7
    s_cselect_b32 s92, 7, 0
    s_sub_u32 s38, s38, s92
    s_waitcnt lgkmcnt(11)
    s_nop 0
    v_mfma_f32_32x32x16_bf16 v[64:79], a[32:35], a[40:43], v[64:79]
    ds_read_b64_tr_b16 a[16:17], v3 offset:8192
    ds_read_b64_tr_b16 a[18:19], v3 offset:8704
    ds_read_b128 a[24:27], v5 offset:128
    s_waitcnt lgkmcnt(9)
    s_barrier
    s_add_u32 m0, s72, 18432
    s_mov_b32 s13, 630784
    buffer_load_dwordx4 v1, s[44:47], s13 offen lds
    v_mfma_f32_32x32x16_bf16 v[80:95], a[36:39], a[40:43], v[80:95]
    ds_read_b64_tr_b16 a[20:21], v4 offset:8192
    ds_read_b64_tr_b16 a[22:23], v4 offset:8704
    ds_read_b128 a[28:31], v6 offset:128
    s_add_u32 m0, s72, 19456
    s_mov_b32 s13, 659456
    buffer_load_dwordx4 v1, s[44:47], s13 offen lds
    v_mfma_f32_32x32x16_bf16 v[96:111], a[32:35], a[44:47], v[96:111]
    s_add_u32 m0, s72, 4096
    s_mov_b32 s13, 688128
    buffer_load_dwordx4 v1, s[44:47], s13 offen lds
    s_mul_i32 s77, s38, 229376
    s_lshl_b32 s38, s38, 15
    s_add_u32 s84, s38, s39
    v_mfma_f32_32x32x16_bf16 v[112:127], a[36:39], a[44:47], v[112:127]
    s_add_u32 m0, s72, 5120
    s_mov_b32 s13, 716800
    buffer_load_dwordx4 v1, s[44:47], s13 offen lds
    s_add_u32 s38, s68, 2
    s_cmp_ge_u32 s38, 7
    s_cselect_b32 s92, 7, 0
    s_sub_u32 s38, s38, s92
    s_waitcnt lgkmcnt(9)
    s_nop 0
    v_mfma_f32_32x32x16_bf16 v[64:79], a[0:3], a[8:11], v[64:79]
    ds_read_b64_tr_b16 a[32:33], v3 offset:10240
    ds_read_b64_tr_b16 a[34:35], v3 offset:10752
    ds_read_b128 a[40:43], v5 offset:160
    s_mul_i32 s78, s38, 229376
    s_lshl_b32 s38, s38, 15
    s_add_u32 s85, s38, s39
    s_waitcnt lgkmcnt(10)
    v_mfma_f32_32x32x16_bf16 v[80:95], a[4:7], a[8:11], v[80:95]
    ds_read_b64_tr_b16 a[36:37], v4 offset:10240
    ds_read_b64_tr_b16 a[38:39], v4 offset:10752
    ds_read_b128 a[44:47], v6 offset:160
    ds_read_b128 a[192:195], v24 offset:0
    s_waitcnt lgkmcnt(13)
    v_mfma_f32_32x32x16_bf16 v[96:111], a[0:3], a[12:15], v[96:111]
    s_add_u32 m0, s72, 6144
    s_mov_b32 s13, 745472
    buffer_load_dwordx4 v1, s[44:47], s13 offen lds
    s_add_u32 s38, s68, 3
    s_cmp_ge_u32 s38, 7
    s_cselect_b32 s92, 7, 0
    s_sub_u32 s38, s38, s92
    v_mfma_f32_32x32x16_bf16 v[112:127], a[4:7], a[12:15], v[112:127]
    s_add_u32 m0, s72, 7168
    s_mov_b32 s13, 774144
    buffer_load_dwordx4 v1, s[44:47], s13 offen lds
    s_mul_i32 s79, s38, 229376
    s_lshl_b32 s38, s38, 15
    s_add_u32 s86, s38, s39
    s_waitcnt lgkmcnt(10)
    v_mfma_f32_32x32x16_bf16 v[64:79], a[16:19], a[24:27], v[64:79]
    ds_read_b64_tr_b16 a[0:1], v3 offset:12288
    ds_read_b64_tr_b16 a[2:3], v3 offset:12800
    ds_read_b128 a[8:11], v5 offset:192
    s_add_u32 s38, s68, 4
    s_cmp_ge_u32 s38, 7
    s_cselect_b32 s92, 7, 0
    s_sub_u32 s38, s38, s92
    s_waitcnt lgkmcnt(11)
    v_mfma_f32_32x32x16_bf16 v[80:95], a[20:23], a[24:27], v[80:95]
    ds_read_b64_tr_b16 a[4:5], v4 offset:12288
    ds_read_b64_tr_b16 a[6:7], v4 offset:12800
    ds_read_b128 a[12:15], v6 offset:192
    ds_read_b128 a[196:199], v24 offset:16
    s_waitcnt lgkmcnt(14)
    s_nop 0
    v_mfma_f32_32x32x16_bf16 v[96:111], a[16:19], a[28:31], v[96:111]
    s_add_u32 m0, s72, 8192
    s_mov_b32 s13, 802816
    buffer_load_dwordx4 v1, s[44:47], s13 offen lds
    s_mul_i32 s80, s38, 229376
    s_lshl_b32 s38, s38, 15
    s_add_u32 s87, s38, s39
    v_mfma_f32_32x32x16_bf16 v[112:127], a[20:23], a[28:31], v[112:127]
    s_add_u32 m0, s72, 9216
    s_mov_b32 s13, 831488
    buffer_load_dwordx4 v1, s[44:47], s13 offen lds
    s_add_u32 s38, s68, 5
    s_cmp_ge_u32 s38, 7
    s_cselect_b32 s92, 7, 0
    s_sub_u32 s38, s38, s92
    s_waitcnt lgkmcnt(11)
    s_nop 0
    v_mfma_f32_32x32x16_bf16 v[64:79], a[32:35], a[40:43], v[64:79]
    ds_read_b64_tr_b16 a[16:17], v3 offset:14336
    ds_read_b64_tr_b16 a[18:19], v3 offset:14848
    ds_read_b128 a[24:27], v5 offset:224
    s_mul_i32 s81, s38, 229376
    s_lshl_b32 s38, s38, 15
    s_add_u32 s88, s38, s39
    s_waitcnt lgkmcnt(12)
    v_mfma_f32_32x32x16_bf16 v[80:95], a[36:39], a[40:43], v[80:95]
    ds_read_b64_tr_b16 a[20:21], v4 offset:14336
    ds_read_b64_tr_b16 a[22:23], v4 offset:14848
    ds_read_b128 a[28:31], v6 offset:224
    ds_read_b128 a[200:203], v25 offset:0
    s_waitcnt lgkmcnt(15)
    v_mfma_f32_32x32x16_bf16 v[96:111], a[32:35], a[44:47], v[96:111]
    s_add_u32 m0, s72, 10240
    s_mov_b32 s13, 860160
    buffer_load_dwordx4 v1, s[44:47], s13 offen lds
    s_add_u32 s38, s68, 6
    s_cmp_ge_u32 s38, 7
    s_cselect_b32 s92, 7, 0
    s_sub_u32 s38, s38, s92
    v_mfma_f32_32x32x16_bf16 v[112:127], a[36:39], a[44:47], v[112:127]
    s_add_u32 m0, s72, 11264
    s_mov_b32 s13, 888832
    buffer_load_dwordx4 v1, s[44:47], s13 offen lds
    s_mul_i32 s82, s38, 229376
    s_lshl_b32 s38, s38, 15
    s_add_u32 s89, s38, s39
    s_waitcnt lgkmcnt(11)
    s_nop 0
    v_mfma_f32_32x32x16_bf16 v[64:79], a[0:3], a[8:11], v[64:79]
    ds_read_b64_tr_b16 a[32:33], v3 offset:16384
    ds_read_b64_tr_b16 a[34:35], v3 offset:16896
    ds_read_b128 a[40:43], v5 offset:256
    s_lshr_b32 s74, s2, 5
    s_lshl_b32 s74, s74, 9
    s_add_u32 s74, s74, 11534336
    v_and_b32 v15, 31, v0
    s_waitcnt lgkmcnt(12)
    v_mfma_f32_32x32x16_bf16 v[80:95], a[4:7], a[8:11], v[80:95]
    ds_read_b64_tr_b16 a[36:37], v4 offset:16384
    ds_read_b64_tr_b16 a[38:39], v4 offset:16896
    ds_read_b128 a[44:47], v6 offset:256
    ds_read_b128 a[204:207], v25 offset:16
    s_waitcnt lgkmcnt(15)
    v_mfma_f32_32x32x16_bf16 v[96:111], a[0:3], a[12:15], v[96:111]
    s_add_u32 m0, s72, 12288
    s_mov_b32 s13, 917504
    buffer_load_dwordx4 v1, s[44:47], s13 offen lds
    v_lshl_add_u32 v15, v15, 4, s74
    s_lshl_b32 s74, s69, 2
    v_mfma_f32_32x32x16_bf16 v[112:127], a[4:7], a[12:15], v[112:127]
    s_add_u32 m0, s72, 13312
    s_mov_b32 s13, 946176
    buffer_load_dwordx4 v1, s[44:47], s13 offen lds
    s_add_u32 s74, s74, s70
    s_lshl_b32 s74, s74, 10
    s_add_u32 s74, s74, 11665408
    v_and_b32_e64 v17, 7, v0
    s_waitcnt lgkmcnt(11)
    v_mfma_f32_32x32x16_bf16 v[64:79], a[16:19], a[24:27], v[64:79]
    s_waitcnt vmcnt(14)
    ds_read_b64_tr_b16 a[0:1], v3 offset:0
    ds_read_b64_tr_b16 a[2:3], v3 offset:512
    ds_read_b128 a[8:11], v5 offset:288
    v_min_u32_e64 v17, 6, v17
    v_lshlrev_b32 v17, 7, v17
    s_waitcnt lgkmcnt(12)
    v_mfma_f32_32x32x16_bf16 v[80:95], a[20:23], a[24:27], v[80:95]
    ds_read_b64_tr_b16 a[4:5], v4 offset:0
    ds_read_b64_tr_b16 a[6:7], v4 offset:512
    ds_read_b128 a[12:15], v6 offset:288
    v_add_u32 v17, s74, v17
    s_add_u32 s7, s14, s74
    s_waitcnt lgkmcnt(14)
    v_mfma_f32_32x32x16_bf16 v[96:111], a[16:19], a[28:31], v[96:111]
    s_add_u32 m0, s72, 14336
    s_mov_b32 s13, 974848
    buffer_load_dwordx4 v1, s[44:47], s13 offen lds
    s_lshl_b32 s74, s2, 1
    s_add_u32 s74, s74, s95
    s_lshl_b32 s74, s74, 12
    v_mfma_f32_32x32x16_bf16 v[112:127], a[20:23], a[28:31], v[112:127]
    s_add_u32 m0, s72, 15360
    s_mov_b32 s13, 1003520
    buffer_load_dwordx4 v1, s[44:47], s13 offen lds
    s_add_u32 s60, s36, s74
    s_addc_u32 s61, s37, 0
    s_mov_b32 s62, 4096
    s_mov_b32 s63, 0x00020000
    s_waitcnt lgkmcnt(10)
    v_mfma_f32_32x32x16_bf16 v[64:79], a[32:35], a[40:43], v[64:79]
    s_waitcnt vmcnt(14)
    ds_read_b64_tr_b16 a[16:17], v3 offset:2048
    ds_read_b64_tr_b16 a[18:19], v3 offset:2560
    ds_read_b128 a[24:27], v5 offset:320
    s_lshl_b32 s73, s94, 11
    s_add_u32 s8, s74, s73
    s_add_u32 s8, s8, 2097152
    v_add_u32 v19, s73, v13
    s_waitcnt lgkmcnt(11)
    v_mfma_f32_32x32x16_bf16 v[80:95], a[36:39], a[40:43], v[80:95]
    ds_read_b64_tr_b16 a[20:21], v4 offset:2048
    ds_read_b64_tr_b16 a[22:23], v4 offset:2560
    ds_read_b128 a[28:31], v6 offset:320
    v_add_u32 v20, -16, v19
    s_waitcnt lgkmcnt(13)
    v_mfma_f32_32x32x16_bf16 v[96:111], a[32:35], a[44:47], v[96:111]
    s_add_u32 m0, s72, 16384
    s_mov_b32 s13, 1032192
    buffer_load_dwordx4 v1, s[44:47], s13 offen lds
    s_cmp_eq_u32 s94, 0
    s_cselect_b32 s74, -16, 4080
    v_and_b32 v21, 2, v0
    v_mfma_f32_32x32x16_bf16 v[112:127], a[36:39], a[44:47], v[112:127]
    s_add_u32 m0, s72, 17408
    s_mov_b32 s13, 1060864
    buffer_load_dwordx4 v1, s[44:47], s13 offen lds
    v_mul_u32_u24_e64 v21, s94, v21
    v_lshl_add_u32 v21, v21, 1, s74
    s_waitcnt lgkmcnt(9)
    v_mfma_f32_32x32x16_bf16 v[64:79], a[0:3], a[8:11], v[64:79]
    s_waitcnt vmcnt(14)
    ds_read_b64_tr_b16 a[32:33], v3 offset:18432
    ds_read_b64_tr_b16 a[34:35], v3 offset:18944
    ds_read_b128 a[40:43], v5 offset:352
    v_and_b32_e64 v30, 1, v0
    v_lshlrev_b32 v30, 4, v30
    s_waitcnt lgkmcnt(10)
    v_mfma_f32_32x32x16_bf16 v[80:95], a[4:7], a[8:11], v[80:95]
    ds_read_b64_tr_b16 a[36:37], v4 offset:18432
    ds_read_b64_tr_b16 a[38:39], v4 offset:18944
    ds_read_b128 a[44:47], v6 offset:352
    s_mul_i32 s11, s95, 16656
    s_add_u32 s74, s11, 16
    v_add_u32 v22, s74, v19
    s_waitcnt lgkmcnt(12)
    v_mfma_f32_32x32x16_bf16 v[96:111], a[0:3], a[12:15], v[96:111]
    s_add_u32 m0, s72, 0
    s_mov_b32 s13, 1089536
    buffer_load_dwordx4 v1, s[44:47], s13 offen lds
    s_mul_i32 s74, s94, 4112
    s_add_u32 s74, s74, s11
    v_and_b32 v23, 3, v0
    v_mfma_f32_32x32x16_bf16 v[112:127], a[4:7], a[12:15], v[112:127]
    s_add_u32 m0, s72, 1024
    s_mov_b32 s13, 1118208
    buffer_load_dwordx4 v1, s[44:47], s13 offen lds
    v_mul_u32_u24 v23, 4160, v23
    v_add_u32_e64 v23, s74, v23
    s_waitcnt lgkmcnt(9)
    v_mfma_f32_32x32x16_bf16 v[64:79], a[16:19], a[24:27], v[64:79]
    s_waitcnt vmcnt(14)
    ds_read_b64_tr_b16 a[0:1], v3 offset:4096
    ds_read_b64_tr_b16 a[2:3], v3 offset:4608
    ds_read_b128 a[8:11], v5 offset:384
    s_mul_i32 s9, s95, 4608
    s_add_u32 s9, s9, 69888
    v_and_b32 v57, 15, v0
    s_waitcnt lgkmcnt(10)
    v_mfma_f32_32x32x16_bf16 v[80:95], a[20:23], a[24:27], v[80:95]
    ds_read_b64_tr_b16 a[4:5], v4 offset:4096
    ds_read_b64_tr_b16 a[6:7], v4 offset:4608
    ds_read_b128 a[12:15], v6 offset:384
    v_add_u32_e64 v58, 1, v57
    v_and_b32 v59, 3, v58
    s_waitcnt lgkmcnt(12)
    v_mfma_f32_32x32x16_bf16 v[96:111], a[16:19], a[28:31], v[96:111]
    s_add_u32 m0, s72, 2048
    s_mov_b32 s13, 1146880
    buffer_load_dwordx4 v1, s[44:47], s13 offen lds
    v_sub_u32_e64 v58, v58, v59
    v_mul_u32_u24 v59, 4160, v59
    v_mfma_f32_32x32x16_bf16 v[112:127], a[20:23], a[28:31], v[112:127]
    s_add_u32 m0, s72, 3072
    s_mov_b32 s13, 1175552
    buffer_load_dwordx4 v1, s[44:47], s13 offen lds
    v_lshl_add_u32 v59, v58, 1, v59
    v_lshrrev_b32_e64 v58, 4, v0
    s_waitcnt lgkmcnt(9)
    v_mfma_f32_32x32x16_bf16 v[64:79], a[32:35], a[40:43], v[64:79]
    s_waitcnt vmcnt(14)
    ds_read_b64_tr_b16 a[16:17], v3 offset:6144
    ds_read_b64_tr_b16 a[18:19], v3 offset:6656
    ds_read_b128 a[24:27], v5 offset:416
    v_lshl_add_u32 v59, v58, 4, v59
    s_lshl_b32 s74, s94, 8
    s_waitcnt lgkmcnt(10)
    v_mfma_f32_32x32x16_bf16 v[80:95], a[36:39], a[40:43], v[80:95]
    ds_read_b64_tr_b16 a[20:21], v4 offset:6144
    ds_read_b64_tr_b16 a[22:23], v4 offset:6656
    ds_read_b128 a[28:31], v6 offset:416
    s_add_u32 s74, s74, s11
    v_add_u32_e64 v24, s74, v59
    s_waitcnt lgkmcnt(12)
    v_mfma_f32_32x32x16_bf16 v[96:111], a[32:35], a[44:47], v[96:111]
    s_add_u32 m0, s72, 18432
    s_mov_b32 s13, 1204224
    buffer_load_dwordx4 v1, s[44:47], s13 offen lds
    v_and_b32_e64 v58, 1, v58
    v_sub_u32_e64 v59, v56, v57
    v_mfma_f32_32x32x16_bf16 v[112:127], a[36:39], a[44:47], v[112:127]
    s_add_u32 m0, s72, 19456
    s_mov_b32 s13, 1232896
    buffer_load_dwordx4 v1, s[44:47], s13 offen lds
    v_add_u32_e64 v59, 15, v59
    v_mul_u32_u24 v25, 2304, v58
    s_waitcnt lgkmcnt(9)
    v_mfma_f32_32x32x16_bf16 v[64:79], a[0:3], a[8:11], v[64:79]
    s_waitcnt vmcnt(14)
    ds_read_b64_tr_b16 a[32:33], v3 offset:8192
    ds_read_b64_tr_b16 a[34:35], v3 offset:8704
    ds_read_b128 a[40:43], v5 offset:448
    v_lshl_add_u32 v25, v59, 4, v25
    s_lshl_b32 s74, s94, 7
    s_waitcnt lgkmcnt(10)
    v_mfma_f32_32x32x16_bf16 v[80:95], a[4:7], a[8:11], v[80:95]
    ds_read_b64_tr_b16 a[36:37], v4 offset:8192
    ds_read_b64_tr_b16 a[38:39], v4 offset:8704
    ds_read_b128 a[44:47], v6 offset:448
    s_add_u32 s74, s74, s9
    v_add_u32_e64 v25, s74, v25
    s_waitcnt lgkmcnt(12)
    v_mfma_f32_32x32x16_bf16 v[96:111], a[0:3], a[12:15], v[96:111]
    s_add_u32 m0, s72, 4096
    s_mov_b32 s13, 1261568
    buffer_load_dwordx4 v1, s[44:47], s13 offen lds
    v_lshlrev_b32_e64 v26, 9, v58
    v_lshl_add_u32 v26, v57, 5, v26
    v_mfma_f32_32x32x16_bf16 v[112:127], a[4:7], a[12:15], v[112:127]
    s_add_u32 m0, s72, 5120
    s_mov_b32 s13, 1290240
    buffer_load_dwordx4 v1, s[44:47], s13 offen lds
    v_lshl_add_u32 v26, v56, 4, v26
    v_add_u32 v27, 4096, v13
    s_waitcnt lgkmcnt(9)
    v_mfma_f32_32x32x16_bf16 v[64:79], a[16:19], a[24:27], v[64:79]
    s_waitcnt vmcnt(14)
    ds_read_b64_tr_b16 a[0:1], v3 offset:10240
    ds_read_b64_tr_b16 a[2:3], v3 offset:10752
    ds_read_b128 a[8:11], v5 offset:480
    v_and_b32 v59, 31, v0
    v_sub_u32 v59, 255, v59
    s_waitcnt lgkmcnt(10)
    v_mfma_f32_32x32x16_bf16 v[80:95], a[20:23], a[24:27], v[80:95]
    ds_read_b64_tr_b16 a[4:5], v4 offset:10240
    ds_read_b64_tr_b16 a[6:7], v4 offset:10752
    ds_read_b128 a[12:15], v6 offset:480
    v_and_b32_e64 v35, 1, v59
    v_lshrrev_b32 v59, 1, v59
    s_waitcnt lgkmcnt(12)
    v_mfma_f32_32x32x16_bf16 v[96:111], a[16:19], a[28:31], v[96:111]
    s_add_u32 m0, s72, 6144
    s_mov_b32 s13, 1318912
    buffer_load_dwordx4 v1, s[44:47], s13 offen lds
    v_mul_u32_u24 v35, 2304, v35
    v_lshl_add_u32 v35, v59, 4, v35
    v_mfma_f32_32x32x16_bf16 v[112:127], a[20:23], a[28:31], v[112:127]
    s_add_u32 m0, s72, 7168
    s_mov_b32 s13, 1347584
    buffer_load_dwordx4 v1, s[44:47], s13 offen lds
    s_sub_u32 s74, s9, 512
    v_add_u32_e64 v35, s74, v35
    s_waitcnt lgkmcnt(9)
    v_mfma_f32_32x32x16_bf16 v[64:79], a[32:35], a[40:43], v[64:79]
    s_waitcnt vmcnt(14)
    ds_read_b64_tr_b16 a[16:17], v3 offset:12288
    ds_read_b64_tr_b16 a[18:19], v3 offset:12800
    ds_read_b128 a[24:27], v5 offset:512
    v_lshlrev_b32_e64 v59, 8, v56
    v_sub_u32 v35, v35, v59
    s_waitcnt lgkmcnt(10)
    v_mfma_f32_32x32x16_bf16 v[80:95], a[36:39], a[40:43], v[80:95]
    ds_read_b64_tr_b16 a[20:21], v4 offset:12288
    ds_read_b64_tr_b16 a[22:23], v4 offset:12800
    ds_read_b128 a[28:31], v6 offset:512
    v_sub_u32 v36, v35, v59
    v_add_u32 v36, -768, v36
    s_waitcnt lgkmcnt(12)
    v_mfma_f32_32x32x16_bf16 v[96:111], a[32:35], a[44:47], v[96:111]
    s_add_u32 m0, s72, 8192
    s_mov_b32 s13, 1376256
    buffer_load_dwordx4 v1, s[44:47], s13 offen lds
    v_mul_u32_u24 v37, 2304, v58
    v_lshl_add_u32 v37, v57, 4, v37
    v_mfma_f32_32x32x16_bf16 v[112:127], a[36:39], a[44:47], v[112:127]
    s_add_u32 m0, s72, 9216
    s_mov_b32 s13, 1404928
    buffer_load_dwordx4 v1, s[44:47], s13 offen lds
    v_add_u32 v37, s9, v37
    s_lshl_b32 s74, s70, 12
    s_waitcnt lgkmcnt(9)
    v_mfma_f32_32x32x16_bf16 v[64:79], a[0:3], a[8:11], v[64:79]
    s_waitcnt vmcnt(14)
    ds_read_b64_tr_b16 a[32:33], v3 offset:14336
    ds_read_b64_tr_b16 a[34:35], v3 offset:14848
    ds_read_b128 a[40:43], v5 offset:544
    v_add_u32 v28, s74, v13
    v_xor_b32 v29, 4096, v28
    s_waitcnt lgkmcnt(10)
    v_mfma_f32_32x32x16_bf16 v[80:95], a[4:7], a[8:11], v[80:95]
    ds_read_b64_tr_b16 a[36:37], v4 offset:14336
    ds_read_b64_tr_b16 a[38:39], v4 offset:14848
    ds_read_b128 a[44:47], v6 offset:544
    s_lshl_b32 s74, s70, 13
    s_add_u32 s12, s74, 33312
    s_sub_u32 s74, s12, s72
    v_xor_b32 v33, 64, v60
    s_waitcnt lgkmcnt(12)
    v_mfma_f32_32x32x16_bf16 v[96:111], a[0:3], a[12:15], v[96:111]
    s_add_u32 m0, s72, 10240
    s_mov_b32 s13, 1433600
    buffer_load_dwordx4 v1, s[44:47], s13 offen lds
    v_add_u32_e64 v31, s74, v60
    v_add_u32_e64 v32, s74, v33
    v_mfma_f32_32x32x16_bf16 v[112:127], a[4:7], a[12:15], v[112:127]
    s_add_u32 m0, s72, 11264
    s_mov_b32 s13, 1462272
    buffer_load_dwordx4 v1, s[44:47], s13 offen lds
    v_add_u32_e64 v8, s72, v13
    v_add_u32_e64 v9, s12, v13
    s_waitcnt lgkmcnt(9)
    v_mfma_f32_32x32x16_bf16 v[64:79], a[16:19], a[24:27], v[64:79]
    s_waitcnt vmcnt(14)
    ds_read_b64_tr_b16 a[0:1], v3 offset:16384
    ds_read_b64_tr_b16 a[2:3], v3 offset:16896
    ds_read_b128 a[8:11], v5 offset:576
    s_lshl_b32 s10, s2, 2
    s_add_u32 s10, s10, s70
    s_lshl_b32 s10, s10, 4
    s_add_u32 s10, s10, 11796480
    s_waitcnt lgkmcnt(10)
    v_mfma_f32_32x32x16_bf16 v[80:95], a[20:23], a[24:27], v[80:95]
    ds_read_b64_tr_b16 a[4:5], v4 offset:16384
    ds_read_b64_tr_b16 a[6:7], v4 offset:16896
    ds_read_b128 a[12:15], v6 offset:576
    s_waitcnt lgkmcnt(12)
    s_nop 0
    v_mfma_f32_32x32x16_bf16 v[96:111], a[16:19], a[28:31], v[96:111]
    s_add_u32 m0, s72, 12288
    s_mov_b32 s13, 1490944
    buffer_load_dwordx4 v1, s[44:47], s13 offen lds
    v_mfma_f32_32x32x16_bf16 v[112:127], a[20:23], a[28:31], v[112:127]
    s_add_u32 m0, s72, 13312
    s_mov_b32 s13, 1519616
    buffer_load_dwordx4 v1, s[44:47], s13 offen lds
    s_waitcnt lgkmcnt(9)
    v_mfma_f32_32x32x16_bf16 v[64:79], a[32:35], a[40:43], v[64:79]
    s_waitcnt vmcnt(14)
    ds_read_b64_tr_b16 a[16:17], v3 offset:0
    ds_read_b64_tr_b16 a[18:19], v3 offset:512
    ds_read_b128 a[24:27], v5 offset:608
    s_waitcnt lgkmcnt(10)
    v_mfma_f32_32x32x16_bf16 v[80:95], a[36:39], a[40:43], v[80:95]
    ds_read_b64_tr_b16 a[20:21], v4 offset:0
    ds_read_b64_tr_b16 a[22:23], v4 offset:512
    ds_read_b128 a[28:31], v6 offset:608
    s_waitcnt lgkmcnt(12)
    v_mfma_f32_32x32x16_bf16 v[96:111], a[32:35], a[44:47], v[96:111]
    s_add_u32 m0, s72, 14336
    s_mov_b32 s13, 1548288
    buffer_load_dwordx4 v1, s[44:47], s13 offen lds
    v_mfma_f32_32x32x16_bf16 v[112:127], a[36:39], a[44:47], v[112:127]
    s_add_u32 m0, s72, 15360
    s_mov_b32 s13, 1576960
    buffer_load_dwordx4 v1, s[44:47], s13 offen lds
    s_waitcnt lgkmcnt(9)
    v_mfma_f32_32x32x16_bf16 v[64:79], a[0:3], a[8:11], v[64:79]
    s_waitcnt vmcnt(14)
    ds_read_b64_tr_b16 a[32:33], v3 offset:2048
    ds_read_b64_tr_b16 a[34:35], v3 offset:2560
    ds_read_b128 a[40:43], v5 offset:640
    v_accvgpr_read_b32 v136, a208
    v_accvgpr_read_b32 v137, a209
    v_accvgpr_read_b32 v138, a210
    s_waitcnt lgkmcnt(10)
    s_nop 0
    v_mfma_f32_32x32x16_bf16 v[80:95], a[4:7], a[8:11], v[80:95]
    ds_read_b64_tr_b16 a[36:37], v4 offset:2048
    ds_read_b64_tr_b16 a[38:39], v4 offset:2560
    ds_read_b128 a[44:47], v6 offset:640
    v_accvgpr_read_b32 v139, a211
    v_accvgpr_read_b32 v140, a212
    v_accvgpr_read_b32 v141, a213
    s_waitcnt lgkmcnt(12)
    v_mfma_f32_32x32x16_bf16 v[96:111], a[0:3], a[12:15], v[96:111]
    s_add_u32 m0, s72, 16384
    s_add_u32 s13, s76, 0
    buffer_load_dwordx4 v2, s[48:51], s13 offen lds
    v_accvgpr_read_b32 v142, a214
    v_accvgpr_read_b32 v143, a215
    v_mfma_f32_32x32x16_bf16 v[112:127], a[4:7], a[12:15], v[112:127]
    s_add_u32 m0, s72, 17408
    s_add_u32 s13, s76, 14336
    buffer_load_dwordx4 v2, s[48:51], s13 offen lds
    v_add_f32_e64 v128, v128, v136
    v_add_f32_e64 v129, v129, v137
    v_add_f32_e64 v130, v130, v138
    s_waitcnt lgkmcnt(9)
    v_mfma_f32_32x32x16_bf16 v[64:79], a[16:19], a[24:27], v[64:79]
    s_waitcnt vmcnt(14)
    ds_read_b64_tr_b16 a[0:1], v3 offset:18432
    ds_read_b64_tr_b16 a[2:3], v3 offset:18944
    ds_read_b128 a[8:11], v5 offset:672
    v_add_f32_e64 v131, v131, v139
    v_add_f32_e64 v132, v132, v140
    v_add_f32 v133, v133, v141
    s_waitcnt lgkmcnt(10)
    v_mfma_f32_32x32x16_bf16 v[80:95], a[20:23], a[24:27], v[80:95]
    ds_read_b64_tr_b16 a[4:5], v4 offset:18432
    ds_read_b64_tr_b16 a[6:7], v4 offset:18944
    ds_read_b128 a[12:15], v6 offset:672
    v_add_f32_e64 v134, v134, v142
    v_add_f32_e64 v135, v135, v143
    v_mov_b32_e64 v160, 0
    s_waitcnt lgkmcnt(12)
    v_mfma_f32_32x32x16_bf16 v[96:111], a[16:19], a[28:31], v[96:111]
    s_add_u32 m0, s72, 0
    s_add_u32 s13, s76, 7168
    buffer_load_dwordx4 v2, s[48:51], s13 offen lds
    v_mov_b32_e64 v161, 0
    v_mov_b32_e64 v162, 0
    v_mov_b32_e64 v163, 0
    v_mfma_f32_32x32x16_bf16 v[112:127], a[20:23], a[28:31], v[112:127]
    s_add_u32 m0, s72, 1024
    s_add_u32 s13, s76, 21504
    buffer_load_dwordx4 v2, s[48:51], s13 offen lds
    v_cvt_pk_bf16_f32 v144, v135, v134
    v_cvt_pk_bf16_f32 v145, v133, v132
    v_cvt_pk_bf16_f32 v146, v131, v130
    s_waitcnt lgkmcnt(9)
    v_mfma_f32_32x32x16_bf16 v[64:79], a[32:35], a[40:43], v[64:79]
    s_waitcnt vmcnt(14)
    ds_read_b64_tr_b16 a[16:17], v3 offset:4096
    ds_read_b64_tr_b16 a[18:19], v3 offset:4608
    ds_read_b128 a[24:27], v5 offset:704
    v_cvt_pk_bf16_f32 v147, v129, v128
    v_cvt_pk_bf16_f32 v148, v130, v130
    v_cvt_pk_bf16_f32 v149, v129, v129
    s_waitcnt lgkmcnt(10)
    s_nop 0
    v_mfma_f32_32x32x16_bf16 v[80:95], a[36:39], a[40:43], v[80:95]
    ds_read_b64_tr_b16 a[20:21], v4 offset:4096
    ds_read_b64_tr_b16 a[22:23], v4 offset:4608
    ds_read_b128 a[28:31], v6 offset:704
    v_cvt_pk_bf16_f32 v150, v129, v128
    v_cvt_pk_bf16_f32 v151, v128, v128
    v_and_b32 v34, 1, v0
    s_waitcnt lgkmcnt(12)
    v_mfma_f32_32x32x16_bf16 v[96:111], a[32:35], a[44:47], v[96:111]
    s_add_u32 m0, s72, 2048
    s_add_u32 s13, s76, 28672
    buffer_load_dwordx4 v2, s[48:51], s13 offen lds
    v_add_u32_e64 v34, -1, v34
    v_mfma_f32_32x32x16_bf16 v[112:127], a[36:39], a[44:47], v[112:127]
    s_add_u32 m0, s72, 3072
    s_add_u32 s13, s76, 43008
    buffer_load_dwordx4 v2, s[48:51], s13 offen lds
    v_bfi_b32 v136, v34, v131, v132
    v_cvt_pk_bf16_f32 v152, v132, v132
    v_cvt_pk_bf16_f32 v154, v131, v131
    s_waitcnt lgkmcnt(9)
    v_mfma_f32_32x32x16_bf16 v[64:79], a[0:3], a[8:11], v[64:79]
    s_waitcnt vmcnt(14)
    ds_read_b64_tr_b16 a[32:33], v3 offset:6144
    ds_read_b64_tr_b16 a[34:35], v3 offset:6656
    ds_read_b128 a[40:43], v5 offset:736
    v_cvt_pk_bf16_f32 v153, v132, v136
    v_mov_b32 v155, v154
    v_bfi_b32 v136, v34, v133, v134
    s_waitcnt lgkmcnt(10)
    v_mfma_f32_32x32x16_bf16 v[80:95], a[4:7], a[8:11], v[80:95]
    ds_read_b64_tr_b16 a[36:37], v4 offset:6144
    ds_read_b64_tr_b16 a[38:39], v4 offset:6656
    ds_read_b128 a[44:47], v6 offset:736
    v_cvt_pk_bf16_f32 v156, v134, v134
    v_cvt_pk_bf16_f32 v158, v133, v133
    v_cvt_pk_bf16_f32 v157, v134, v136
    s_waitcnt lgkmcnt(12)
    s_nop 0
    v_mfma_f32_32x32x16_bf16 v[96:111], a[0:3], a[12:15], v[96:111]
    s_add_u32 m0, s72, 18432
    s_add_u32 s13, s76, 35840
    buffer_load_dwordx4 v2, s[48:51], s13 offen lds
    v_mov_b32_e64 v159, v158
    v_mfma_f32_32x32x16_bf16 v[112:127], a[4:7], a[12:15], v[112:127]
    s_add_u32 m0, s72, 19456
    s_add_u32 s13, s76, 50176
    buffer_load_dwordx4 v2, s[48:51], s13 offen lds
    s_waitcnt lgkmcnt(9)
    v_mfma_f32_32x32x16_bf16 v[64:79], a[16:19], a[24:27], v[64:79]
    s_waitcnt vmcnt(14)
    ds_read_b64_tr_b16 a[0:1], v3 offset:8192
    ds_read_b64_tr_b16 a[2:3], v3 offset:8704
    ds_read_b128 a[8:11], v5 offset:768
    s_waitcnt lgkmcnt(10)
    s_nop 0
    v_mfma_f32_32x32x16_bf16 v[80:95], a[20:23], a[24:27], v[80:95]
    ds_read_b64_tr_b16 a[4:5], v4 offset:8192
    ds_read_b64_tr_b16 a[6:7], v4 offset:8704
    ds_read_b128 a[12:15], v6 offset:768
    buffer_load_dword v14, v15, s[52:55], 0 offen sc1
    s_waitcnt lgkmcnt(12)
    v_mfma_f32_32x32x16_bf16 v[96:111], a[16:19], a[28:31], v[96:111]
    s_add_u32 m0, s72, 4096
    s_add_u32 s13, s77, 0
    buffer_load_dwordx4 v2, s[48:51], s13 offen lds
    v_mfma_f32_32x32x16_bf16 v[112:127], a[20:23], a[28:31], v[112:127]
    s_add_u32 m0, s72, 5120
    s_add_u32 s13, s77, 14336
    buffer_load_dwordx4 v2, s[48:51], s13 offen lds
    s_waitcnt lgkmcnt(9)
    v_mfma_f32_32x32x16_bf16 v[64:79], a[32:35], a[40:43], v[64:79]
    s_waitcnt vmcnt(15)
    ds_read_b64_tr_b16 a[16:17], v3 offset:10240
    ds_read_b64_tr_b16 a[18:19], v3 offset:10752
    ds_read_b128 a[24:27], v5 offset:800
    s_waitcnt lgkmcnt(10)
    v_mfma_f32_32x32x16_bf16 v[80:95], a[36:39], a[40:43], v[80:95]
    ds_read_b64_tr_b16 a[20:21], v4 offset:10240
    ds_read_b64_tr_b16 a[22:23], v4 offset:10752
    ds_read_b128 a[28:31], v6 offset:800
    s_waitcnt lgkmcnt(12)
    v_mfma_f32_32x32x16_bf16 v[96:111], a[32:35], a[44:47], v[96:111]
    s_add_u32 m0, s72, 6144
    s_add_u32 s13, s77, 7168
    buffer_load_dwordx4 v2, s[48:51], s13 offen lds
    v_mfma_f32_32x32x16_bf16 v[112:127], a[36:39], a[44:47], v[112:127]
    s_add_u32 m0, s72, 7168
    s_add_u32 s13, s77, 21504
    buffer_load_dwordx4 v2, s[48:51], s13 offen lds
    s_waitcnt lgkmcnt(9)
    v_mfma_f32_32x32x16_bf16 v[64:79], a[0:3], a[8:11], v[64:79]
    s_waitcnt vmcnt(15)
    ds_read_b64_tr_b16 a[32:33], v3 offset:12288
    ds_read_b64_tr_b16 a[34:35], v3 offset:12800
    ds_read_b128 a[40:43], v5 offset:832
    s_waitcnt lgkmcnt(10)
    v_mfma_f32_32x32x16_bf16 v[80:95], a[4:7], a[8:11], v[80:95]
    ds_read_b64_tr_b16 a[36:37], v4 offset:12288
    ds_read_b64_tr_b16 a[38:39], v4 offset:12800
    ds_read_b128 a[44:47], v6 offset:832
    s_waitcnt lgkmcnt(12)
    v_mfma_f32_32x32x16_bf16 v[96:111], a[0:3], a[12:15], v[96:111]
    s_add_u32 m0, s72, 8192
    s_add_u32 s13, s77, 28672
    buffer_load_dwordx4 v2, s[48:51], s13 offen lds
    v_mfma_f32_32x32x16_bf16 v[112:127], a[4:7], a[12:15], v[112:127]
    s_add_u32 m0, s72, 9216
    s_add_u32 s13, s77, 43008
    buffer_load_dwordx4 v2, s[48:51], s13 offen lds
    s_waitcnt lgkmcnt(9)
    v_mfma_f32_32x32x16_bf16 v[64:79], a[16:19], a[24:27], v[64:79]
    s_waitcnt vmcnt(15)
    ds_read_b64_tr_b16 a[0:1], v3 offset:14336
    ds_read_b64_tr_b16 a[2:3], v3 offset:14848
    ds_read_b128 a[8:11], v5 offset:864
    s_waitcnt lgkmcnt(10)
    v_mfma_f32_32x32x16_bf16 v[80:95], a[20:23], a[24:27], v[80:95]
    ds_read_b64_tr_b16 a[4:5], v4 offset:14336
    ds_read_b64_tr_b16 a[6:7], v4 offset:14848
    ds_read_b128 a[12:15], v6 offset:864
    s_waitcnt lgkmcnt(12)
    v_mfma_f32_32x32x16_bf16 v[96:111], a[16:19], a[28:31], v[96:111]
    s_add_u32 m0, s72, 10240
    s_add_u32 s13, s77, 35840
    buffer_load_dwordx4 v2, s[48:51], s13 offen lds
    v_mfma_f32_32x32x16_bf16 v[112:127], a[20:23], a[28:31], v[112:127]
    s_add_u32 m0, s72, 11264
    s_add_u32 s13, s77, 50176
    buffer_load_dwordx4 v2, s[48:51], s13 offen lds
    s_waitcnt lgkmcnt(9)
    v_mfma_f32_32x32x16_bf16 v[64:79], a[32:35], a[40:43], v[64:79]
    s_waitcnt lgkmcnt(7)
    v_mfma_f32_32x32x16_bf16 v[80:95], a[36:39], a[40:43], v[80:95]
    s_waitcnt lgkmcnt(6)
    v_mfma_f32_32x32x16_bf16 v[96:111], a[32:35], a[44:47], v[96:111]
    s_add_u32 m0, s72, 12288
    s_add_u32 s13, s78, 0
    buffer_load_dwordx4 v2, s[48:51], s13 offen lds
    v_mfma_f32_32x32x16_bf16 v[112:127], a[36:39], a[44:47], v[112:127]
    s_add_u32 m0, s72, 13312
    s_add_u32 s13, s78, 14336
    buffer_load_dwordx4 v2, s[48:51], s13 offen lds
    s_waitcnt lgkmcnt(3)
    s_nop 0
    v_mfma_f32_32x32x16_bf16 v[64:79], a[0:3], a[8:11], v[64:79]
    s_waitcnt lgkmcnt(1)
    v_mfma_f32_32x32x16_bf16 v[80:95], a[4:7], a[8:11], v[80:95]
    s_waitcnt lgkmcnt(0)
    v_mfma_f32_32x32x16_bf16 v[96:111], a[0:3], a[12:15], v[96:111]
    s_add_u32 m0, s72, 14336
    s_add_u32 s13, s78, 7168
    buffer_load_dwordx4 v2, s[48:51], s13 offen lds
    v_mfma_f32_32x32x16_bf16 v[112:127], a[4:7], a[12:15], v[112:127]
    s_add_u32 m0, s72, 15360
    s_add_u32 s13, s78, 21504
    buffer_load_dwordx4 v2, s[48:51], s13 offen lds
    s_waitcnt vmcnt(12)
    v_cmp_ne_u32 vcc, s71, v14
    s_nop 0
    s_and_b64 vcc, vcc, exec
    s_nop 4
    s_cbranch_scc0 P2_ok
    s_mov_b32 s99, 0x40000
P2_lp:
    buffer_load_dword v14, v15, s[52:55], 0 offen sc1
    s_waitcnt vmcnt(0)
    s_sub_u32 s99, s99, 1
    s_cbranch_scc1 P2_ok
    v_cmp_ne_u32 vcc, s71, v14
    s_nop 0
    s_and_b64 vcc, vcc, exec
    s_cbranch_scc1 P2_lp
P2_ok:
    s_barrier
    s_mov_b32 s90, 0xbdd2d3e8
    s_mov_b32 s91, 0xc0135761
    buffer_load_dwordx4 v[40:43], v20, s[60:63], 0 offen sc1
    buffer_load_dwordx2 v[44:45], v19, s[60:63], 0 offen sc1
    buffer_load_dwordx4 v[46:49], v19, s[60:63], 0 offen offset:1008 sc1
    buffer_load_dwordx2 v[50:51], v19, s[60:63], 0 offen offset:1024 sc1
    buffer_load_dwordx4 v[52:55], v21, s[60:63], 0 offen sc1
    v_pk_mul_f32 v[128:129], v[64:65], v[64:65]
    v_pk_mul_f32 v[130:131], v[66:67], v[66:67]
    v_pk_mul_f32 v[132:133], v[68:69], v[68:69]
    v_pk_mul_f32 v[134:135], v[70:71], v[70:71]
    v_pk_fma_f32 v[128:129], v[128:129], s[90:91], s[90:91] op_sel:[0,0,1] op_sel_hi:[1,0,1]
    v_pk_fma_f32 v[130:131], v[130:131], s[90:91], s[90:91] op_sel:[0,0,1] op_sel_hi:[1,0,1]
    v_pk_fma_f32 v[132:133], v[132:133], s[90:91], s[90:91] op_sel:[0,0,1] op_sel_hi:[1,0,1]
    v_pk_fma_f32 v[134:135], v[134:135], s[90:91], s[90:91] op_sel:[0,0,1] op_sel_hi:[1,0,1]
    v_pk_mul_f32 v[128:129], v[128:129], v[64:65]
    v_pk_mul_f32 v[130:131], v[130:131], v[66:67]
    v_pk_mul_f32 v[132:133], v[132:133], v[68:69]
    v_pk_mul_f32 v[134:135], v[134:135], v[70:71]
    v_exp_f32_e64 v128, v128
    v_exp_f32_e64 v129, v129
    v_exp_f32_e64 v130, v130
    v_exp_f32_e64 v131, v131
    v_exp_f32_e64 v132, v132
    v_exp_f32_e64 v133, v133
    v_exp_f32_e64 v134, v134
    v_exp_f32_e64 v135, v135
    v_pk_add_f32 v[128:129], v[128:129], 1.0 op_sel_hi:[1,0]
    v_pk_add_f32 v[130:131], v[130:131], 1.0 op_sel_hi:[1,0]
    v_pk_add_f32 v[132:133], v[132:133], 1.0 op_sel_hi:[1,0]
    v_pk_add_f32 v[134:135], v[134:135], 1.0 op_sel_hi:[1,0]
    v_rcp_f32_e64 v128, v128
    v_rcp_f32_e64 v129, v129
    v_rcp_f32_e64 v130, v130
    v_rcp_f32_e64 v131, v131
    v_rcp_f32_e64 v132, v132
    v_rcp_f32_e64 v133, v133
    v_rcp_f32_e64 v134, v134
    v_rcp_f32_e64 v135, v135
    v_pk_mul_f32 v[128:129], v[128:129], v[64:65]
    v_pk_mul_f32 v[130:131], v[130:131], v[66:67]
    v_pk_mul_f32 v[132:133], v[132:133], v[68:69]
    v_pk_mul_f32 v[134:135], v[134:135], v[70:71]
    v_cvt_pk_bf16_f32 v224, v128, v129
    v_cvt_pk_bf16_f32 v225, v130, v131
    v_cvt_pk_bf16_f32 v226, v132, v133
    v_cvt_pk_bf16_f32 v227, v134, v135
    buffer_store_dwordx4 v[224:227], v13, s[52:55], s83 offen offset:0 sc1
    s_add_u32 m0, s12, 0
    s_nop 0
    s_add_u32 s13, s78, 28672
    buffer_load_dwordx4 v2, s[48:51], s13 offen lds
    v_pk_mul_f32 v[128:129], v[72:73], v[72:73]
    v_pk_mul_f32 v[130:131], v[74:75], v[74:75]
    v_pk_mul_f32 v[132:133], v[76:77], v[76:77]
    v_pk_mul_f32 v[134:135], v[78:79], v[78:79]
    v_pk_fma_f32 v[128:129], v[128:129], s[90:91], s[90:91] op_sel:[0,0,1] op_sel_hi:[1,0,1]
    v_pk_fma_f32 v[130:131], v[130:131], s[90:91], s[90:91] op_sel:[0,0,1] op_sel_hi:[1,0,1]
    v_pk_fma_f32 v[132:133], v[132:133], s[90:91], s[90:91] op_sel:[0,0,1] op_sel_hi:[1,0,1]
    v_pk_fma_f32 v[134:135], v[134:135], s[90:91], s[90:91] op_sel:[0,0,1] op_sel_hi:[1,0,1]
    v_pk_mul_f32 v[128:129], v[128:129], v[72:73]
    v_pk_mul_f32 v[130:131], v[130:131], v[74:75]
    v_pk_mul_f32 v[132:133], v[132:133], v[76:77]
    v_pk_mul_f32 v[134:135], v[134:135], v[78:79]
    v_exp_f32_e64 v128, v128
    v_exp_f32_e64 v129, v129
    v_exp_f32_e64 v130, v130
    v_exp_f32_e64 v131, v131
    v_exp_f32_e64 v132, v132
    v_exp_f32_e64 v133, v133
    v_exp_f32_e64 v134, v134
    v_exp_f32_e64 v135, v135
    v_pk_add_f32 v[128:129], v[128:129], 1.0 op_sel_hi:[1,0]
    v_pk_add_f32 v[130:131], v[130:131], 1.0 op_sel_hi:[1,0]
    v_pk_add_f32 v[132:133], v[132:133], 1.0 op_sel_hi:[1,0]
    v_pk_add_f32 v[134:135], v[134:135], 1.0 op_sel_hi:[1,0]
    v_rcp_f32_e64 v128, v128
    v_rcp_f32_e64 v129, v129
    v_rcp_f32_e64 v130, v130
    v_rcp_f32_e64 v131, v131
    v_rcp_f32_e64 v132, v132
    v_rcp_f32_e64 v133, v133
    v_rcp_f32_e64 v134, v134
    v_rcp_f32_e64 v135, v135
    v_pk_mul_f32 v[128:129], v[128:129], v[72:73]
    v_pk_mul_f32 v[130:131], v[130:131], v[74:75]
    v_pk_mul_f32 v[132:133], v[132:133], v[76:77]
    v_pk_mul_f32 v[134:135], v[134:135], v[78:79]
    v_cvt_pk_bf16_f32 v228, v128, v129
    v_cvt_pk_bf16_f32 v229, v130, v131
    v_cvt_pk_bf16_f32 v230, v132, v133
    v_cvt_pk_bf16_f32 v231, v134, v135
    buffer_store_dwordx4 v[228:231], v13, s[52:55], s83 offen offset:1024 sc1
    s_add_u32 m0, s12, 1024
    s_add_u32 s13, s78, 43008
    buffer_load_dwordx4 v2, s[48:51], s13 offen lds
    v_pk_mul_f32 v[128:129], v[80:81], v[80:81]
    v_pk_mul_f32 v[130:131], v[82:83], v[82:83]
    v_pk_mul_f32 v[132:133], v[84:85], v[84:85]
    v_pk_mul_f32 v[134:135], v[86:87], v[86:87]
    v_pk_fma_f32 v[128:129], v[128:129], s[90:91], s[90:91] op_sel:[0,0,1] op_sel_hi:[1,0,1]
    v_pk_fma_f32 v[130:131], v[130:131], s[90:91], s[90:91] op_sel:[0,0,1] op_sel_hi:[1,0,1]
    v_pk_fma_f32 v[132:133], v[132:133], s[90:91], s[90:91] op_sel:[0,0,1] op_sel_hi:[1,0,1]
    v_pk_fma_f32 v[134:135], v[134:135], s[90:91], s[90:91] op_sel:[0,0,1] op_sel_hi:[1,0,1]
    v_pk_mul_f32 v[128:129], v[128:129], v[80:81]
    v_pk_mul_f32 v[130:131], v[130:131], v[82:83]
    v_pk_mul_f32 v[132:133], v[132:133], v[84:85]
    v_pk_mul_f32 v[134:135], v[134:135], v[86:87]
    v_exp_f32_e64 v128, v128
    v_exp_f32_e64 v129, v129
    v_exp_f32_e64 v130, v130
    v_exp_f32_e64 v131, v131
    v_exp_f32_e64 v132, v132
    v_exp_f32_e64 v133, v133
    v_exp_f32_e64 v134, v134
    v_exp_f32_e64 v135, v135
    v_pk_add_f32 v[128:129], v[128:129], 1.0 op_sel_hi:[1,0]
    v_pk_add_f32 v[130:131], v[130:131], 1.0 op_sel_hi:[1,0]
    v_pk_add_f32 v[132:133], v[132:133], 1.0 op_sel_hi:[1,0]
    v_pk_add_f32 v[134:135], v[134:135], 1.0 op_sel_hi:[1,0]
    v_rcp_f32_e64 v128, v128
    v_rcp_f32_e64 v129, v129
    v_rcp_f32_e64 v130, v130
    v_rcp_f32_e64 v131, v131
    v_rcp_f32_e64 v132, v132
    v_rcp_f32_e64 v133, v133
    v_rcp_f32_e64 v134, v134
    v_rcp_f32_e64 v135, v135
    v_pk_mul_f32 v[128:129], v[128:129], v[80:81]
    v_pk_mul_f32 v[130:131], v[130:131], v[82:83]
    v_pk_mul_f32 v[132:133], v[132:133], v[84:85]
    v_pk_mul_f32 v[134:135], v[134:135], v[86:87]
    v_cvt_pk_bf16_f32 v232, v128, v129
    v_cvt_pk_bf16_f32 v233, v130, v131
    v_cvt_pk_bf16_f32 v234, v132, v133
    v_cvt_pk_bf16_f32 v235, v134, v135
    buffer_store_dwordx4 v[232:235], v13, s[52:55], s83 offen offset:2048 sc1
    s_add_u32 m0, s12, 2048
    s_add_u32 s13, s78, 35840
    buffer_load_dwordx4 v2, s[48:51], s13 offen lds
    v_pk_mul_f32 v[128:129], v[88:89], v[88:89]
    v_pk_mul_f32 v[130:131], v[90:91], v[90:91]
    v_pk_mul_f32 v[132:133], v[92:93], v[92:93]
    v_pk_mul_f32 v[134:135], v[94:95], v[94:95]
    v_pk_fma_f32 v[128:129], v[128:129], s[90:91], s[90:91] op_sel:[0,0,1] op_sel_hi:[1,0,1]
    v_pk_fma_f32 v[130:131], v[130:131], s[90:91], s[90:91] op_sel:[0,0,1] op_sel_hi:[1,0,1]
    v_pk_fma_f32 v[132:133], v[132:133], s[90:91], s[90:91] op_sel:[0,0,1] op_sel_hi:[1,0,1]
    v_pk_fma_f32 v[134:135], v[134:135], s[90:91], s[90:91] op_sel:[0,0,1] op_sel_hi:[1,0,1]
    v_pk_mul_f32 v[128:129], v[128:129], v[88:89]
    v_pk_mul_f32 v[130:131], v[130:131], v[90:91]
    v_pk_mul_f32 v[132:133], v[132:133], v[92:93]
    v_pk_mul_f32 v[134:135], v[134:135], v[94:95]
    v_exp_f32_e64 v128, v128
    v_exp_f32_e64 v129, v129
    v_exp_f32_e64 v130, v130
    v_exp_f32_e64 v131, v131
    v_exp_f32_e64 v132, v132
    v_exp_f32_e64 v133, v133
    v_exp_f32_e64 v134, v134
    v_exp_f32_e64 v135, v135
    v_pk_add_f32 v[128:129], v[128:129], 1.0 op_sel_hi:[1,0]
    v_pk_add_f32 v[130:131], v[130:131], 1.0 op_sel_hi:[1,0]
    v_pk_add_f32 v[132:133], v[132:133], 1.0 op_sel_hi:[1,0]
    v_pk_add_f32 v[134:135], v[134:135], 1.0 op_sel_hi:[1,0]
    v_rcp_f32_e64 v128, v128
    v_rcp_f32_e64 v129, v129
    v_rcp_f32_e64 v130, v130
    v_rcp_f32_e64 v131, v131
    v_rcp_f32_e64 v132, v132
    v_rcp_f32_e64 v133, v133
    v_rcp_f32_e64 v134, v134
    v_rcp_f32_e64 v135, v135
    v_pk_mul_f32 v[128:129], v[128:129], v[88:89]
    v_pk_mul_f32 v[130:131], v[130:131], v[90:91]
    v_pk_mul_f32 v[132:133], v[132:133], v[92:93]
    v_pk_mul_f32 v[134:135], v[134:135], v[94:95]
    v_cvt_pk_bf16_f32 v236, v128, v129
    v_cvt_pk_bf16_f32 v237, v130, v131
    v_cvt_pk_bf16_f32 v238, v132, v133
    v_cvt_pk_bf16_f32 v239, v134, v135
    buffer_store_dwordx4 v[236:239], v13, s[52:55], s83 offen offset:3072 sc1
    s_add_u32 m0, s12, 3072
    s_add_u32 s13, s78, 50176
    buffer_load_dwordx4 v2, s[48:51], s13 offen lds
    v_pk_mul_f32 v[128:129], v[96:97], v[96:97]
    v_pk_mul_f32 v[130:131], v[98:99], v[98:99]
    v_pk_mul_f32 v[132:133], v[100:101], v[100:101]
    v_pk_mul_f32 v[134:135], v[102:103], v[102:103]
    v_pk_fma_f32 v[128:129], v[128:129], s[90:91], s[90:91] op_sel:[0,0,1] op_sel_hi:[1,0,1]
    v_pk_fma_f32 v[130:131], v[130:131], s[90:91], s[90:91] op_sel:[0,0,1] op_sel_hi:[1,0,1]
    v_pk_fma_f32 v[132:133], v[132:133], s[90:91], s[90:91] op_sel:[0,0,1] op_sel_hi:[1,0,1]
    v_pk_fma_f32 v[134:135], v[134:135], s[90:91], s[90:91] op_sel:[0,0,1] op_sel_hi:[1,0,1]
    v_pk_mul_f32 v[128:129], v[128:129], v[96:97]
    v_pk_mul_f32 v[130:131], v[130:131], v[98:99]
    v_pk_mul_f32 v[132:133], v[132:133], v[100:101]
    v_pk_mul_f32 v[134:135], v[134:135], v[102:103]
    v_exp_f32_e64 v128, v128
    v_exp_f32_e64 v129, v129
    v_exp_f32_e64 v130, v130
    v_exp_f32_e64 v131, v131
    v_exp_f32_e64 v132, v132
    v_exp_f32_e64 v133, v133
    v_exp_f32_e64 v134, v134
    v_exp_f32_e64 v135, v135
    v_pk_add_f32 v[128:129], v[128:129], 1.0 op_sel_hi:[1,0]
    v_pk_add_f32 v[130:131], v[130:131], 1.0 op_sel_hi:[1,0]
    v_pk_add_f32 v[132:133], v[132:133], 1.0 op_sel_hi:[1,0]
    v_pk_add_f32 v[134:135], v[134:135], 1.0 op_sel_hi:[1,0]
    v_rcp_f32_e64 v128, v128
    v_rcp_f32_e64 v129, v129
    v_rcp_f32_e64 v130, v130
    v_rcp_f32_e64 v131, v131
    v_rcp_f32_e64 v132, v132
    v_rcp_f32_e64 v133, v133
    v_rcp_f32_e64 v134, v134
    v_rcp_f32_e64 v135, v135
    v_pk_mul_f32 v[128:129], v[128:129], v[96:97]
    v_pk_mul_f32 v[130:131], v[130:131], v[98:99]
    v_pk_mul_f32 v[132:133], v[132:133], v[100:101]
    v_pk_mul_f32 v[134:135], v[134:135], v[102:103]
    v_cvt_pk_bf16_f32 v240, v128, v129
    v_cvt_pk_bf16_f32 v241, v130, v131
    v_cvt_pk_bf16_f32 v242, v132, v133
    v_cvt_pk_bf16_f32 v243, v134, v135
    buffer_store_dwordx4 v[240:243], v27, s[52:55], s83 offen offset:0 sc1
    s_add_u32 m0, s12, 4096
    s_add_u32 s13, s79, 0
    s_nop 0
    buffer_load_dwordx4 v2, s[48:51], s13 offen lds
    v_pk_mul_f32 v[128:129], v[104:105], v[104:105]
    v_pk_mul_f32 v[130:131], v[106:107], v[106:107]
    v_pk_mul_f32 v[132:133], v[108:109], v[108:109]
    v_pk_mul_f32 v[134:135], v[110:111], v[110:111]
    v_pk_fma_f32 v[128:129], v[128:129], s[90:91], s[90:91] op_sel:[0,0,1] op_sel_hi:[1,0,1]
    v_pk_fma_f32 v[130:131], v[130:131], s[90:91], s[90:91] op_sel:[0,0,1] op_sel_hi:[1,0,1]
    v_pk_fma_f32 v[132:133], v[132:133], s[90:91], s[90:91] op_sel:[0,0,1] op_sel_hi:[1,0,1]
    v_pk_fma_f32 v[134:135], v[134:135], s[90:91], s[90:91] op_sel:[0,0,1] op_sel_hi:[1,0,1]
    v_pk_mul_f32 v[128:129], v[128:129], v[104:105]
    v_pk_mul_f32 v[130:131], v[130:131], v[106:107]
    v_pk_mul_f32 v[132:133], v[132:133], v[108:109]
    v_pk_mul_f32 v[134:135], v[134:135], v[110:111]
    v_exp_f32_e64 v128, v128
    v_exp_f32_e64 v129, v129
    v_exp_f32_e64 v130, v130
    v_exp_f32_e64 v131, v131
    v_exp_f32_e64 v132, v132
    v_exp_f32_e64 v133, v133
    v_exp_f32_e64 v134, v134
    v_exp_f32_e64 v135, v135
    v_pk_add_f32 v[128:129], v[128:129], 1.0 op_sel_hi:[1,0]
    v_pk_add_f32 v[130:131], v[130:131], 1.0 op_sel_hi:[1,0]
    v_pk_add_f32 v[132:133], v[132:133], 1.0 op_sel_hi:[1,0]
    v_pk_add_f32 v[134:135], v[134:135], 1.0 op_sel_hi:[1,0]
    v_rcp_f32_e64 v128, v128
    v_rcp_f32_e64 v129, v129
    v_rcp_f32_e64 v130, v130
    v_rcp_f32_e64 v131, v131
    v_rcp_f32_e64 v132, v132
    v_rcp_f32_e64 v133, v133
    v_rcp_f32_e64 v134, v134
    v_rcp_f32_e64 v135, v135
    v_pk_mul_f32 v[128:129], v[128:129], v[104:105]
    v_pk_mul_f32 v[130:131], v[130:131], v[106:107]
    v_pk_mul_f32 v[132:133], v[132:133], v[108:109]
    v_pk_mul_f32 v[134:135], v[134:135], v[110:111]
    v_cvt_pk_bf16_f32 v244, v128, v129
    v_cvt_pk_bf16_f32 v245, v130, v131
    v_cvt_pk_bf16_f32 v246, v132, v133
    v_cvt_pk_bf16_f32 v247, v134, v135
    buffer_store_dwordx4 v[244:247], v27, s[52:55], s83 offen offset:1024 sc1
    s_add_u32 m0, s12, 5120
    s_add_u32 s13, s79, 14336
    buffer_load_dwordx4 v2, s[48:51], s13 offen lds
    v_pk_mul_f32 v[128:129], v[112:113], v[112:113]
    v_pk_mul_f32 v[130:131], v[114:115], v[114:115]
    v_pk_mul_f32 v[132:133], v[116:117], v[116:117]
    v_pk_mul_f32 v[134:135], v[118:119], v[118:119]
    v_pk_fma_f32 v[128:129], v[128:129], s[90:91], s[90:91] op_sel:[0,0,1] op_sel_hi:[1,0,1]
    v_pk_fma_f32 v[130:131], v[130:131], s[90:91], s[90:91] op_sel:[0,0,1] op_sel_hi:[1,0,1]
    v_pk_fma_f32 v[132:133], v[132:133], s[90:91], s[90:91] op_sel:[0,0,1] op_sel_hi:[1,0,1]
    v_pk_fma_f32 v[134:135], v[134:135], s[90:91], s[90:91] op_sel:[0,0,1] op_sel_hi:[1,0,1]
    v_pk_mul_f32 v[128:129], v[128:129], v[112:113]
    v_pk_mul_f32 v[130:131], v[130:131], v[114:115]
    v_pk_mul_f32 v[132:133], v[132:133], v[116:117]
    v_pk_mul_f32 v[134:135], v[134:135], v[118:119]
    v_exp_f32_e64 v128, v128
    v_exp_f32_e64 v129, v129
    v_exp_f32_e64 v130, v130
    v_exp_f32_e64 v131, v131
    v_exp_f32_e64 v132, v132
    v_exp_f32_e64 v133, v133
    v_exp_f32_e64 v134, v134
    v_exp_f32_e64 v135, v135
    v_pk_add_f32 v[128:129], v[128:129], 1.0 op_sel_hi:[1,0]
    v_pk_add_f32 v[130:131], v[130:131], 1.0 op_sel_hi:[1,0]
    v_pk_add_f32 v[132:133], v[132:133], 1.0 op_sel_hi:[1,0]
    v_pk_add_f32 v[134:135], v[134:135], 1.0 op_sel_hi:[1,0]
    v_rcp_f32_e64 v128, v128
    v_rcp_f32_e64 v129, v129
    v_rcp_f32_e64 v130, v130
    v_rcp_f32_e64 v131, v131
    v_rcp_f32_e64 v132, v132
    v_rcp_f32_e64 v133, v133
    v_rcp_f32_e64 v134, v134
    v_rcp_f32_e64 v135, v135
    v_pk_mul_f32 v[128:129], v[128:129], v[112:113]
    v_pk_mul_f32 v[130:131], v[130:131], v[114:115]
    v_pk_mul_f32 v[132:133], v[132:133], v[116:117]
    v_pk_mul_f32 v[134:135], v[134:135], v[118:119]
    v_cvt_pk_bf16_f32 v248, v128, v129
    v_cvt_pk_bf16_f32 v249, v130, v131
    v_cvt_pk_bf16_f32 v250, v132, v133
    v_cvt_pk_bf16_f32 v251, v134, v135
    buffer_store_dwordx4 v[248:251], v27, s[52:55], s83 offen offset:2048 sc1
    s_add_u32 m0, s12, 6144
    s_add_u32 s13, s79, 7168
    buffer_load_dwordx4 v2, s[48:51], s13 offen lds
    v_pk_mul_f32 v[128:129], v[120:121], v[120:121]
    v_pk_mul_f32 v[130:131], v[122:123], v[122:123]
    v_pk_mul_f32 v[132:133], v[124:125], v[124:125]
    v_pk_mul_f32 v[134:135], v[126:127], v[126:127]
    v_pk_fma_f32 v[128:129], v[128:129], s[90:91], s[90:91] op_sel:[0,0,1] op_sel_hi:[1,0,1]
    v_pk_fma_f32 v[130:131], v[130:131], s[90:91], s[90:91] op_sel:[0,0,1] op_sel_hi:[1,0,1]
    v_pk_fma_f32 v[132:133], v[132:133], s[90:91], s[90:91] op_sel:[0,0,1] op_sel_hi:[1,0,1]
    v_pk_fma_f32 v[134:135], v[134:135], s[90:91], s[90:91] op_sel:[0,0,1] op_sel_hi:[1,0,1]
    v_pk_mul_f32 v[128:129], v[128:129], v[120:121]
    v_pk_mul_f32 v[130:131], v[130:131], v[122:123]
    v_pk_mul_f32 v[132:133], v[132:133], v[124:125]
    v_pk_mul_f32 v[134:135], v[134:135], v[126:127]
    v_exp_f32_e64 v128, v128
    v_exp_f32_e64 v129, v129
    v_exp_f32_e64 v130, v130
    v_exp_f32_e64 v131, v131
    v_exp_f32_e64 v132, v132
    v_exp_f32_e64 v133, v133
    v_exp_f32_e64 v134, v134
    v_exp_f32_e64 v135, v135
    v_pk_add_f32 v[128:129], v[128:129], 1.0 op_sel_hi:[1,0]
    v_pk_add_f32 v[130:131], v[130:131], 1.0 op_sel_hi:[1,0]
    v_pk_add_f32 v[132:133], v[132:133], 1.0 op_sel_hi:[1,0]
    v_pk_add_f32 v[134:135], v[134:135], 1.0 op_sel_hi:[1,0]
    v_rcp_f32_e64 v128, v128
    v_rcp_f32_e64 v129, v129
    v_rcp_f32_e64 v130, v130
    v_rcp_f32_e64 v131, v131
    v_rcp_f32_e64 v132, v132
    v_rcp_f32_e64 v133, v133
    v_rcp_f32_e64 v134, v134
    v_rcp_f32_e64 v135, v135
    v_pk_mul_f32 v[128:129], v[128:129], v[120:121]
    v_pk_mul_f32 v[130:131], v[130:131], v[122:123]
    v_pk_mul_f32 v[132:133], v[132:133], v[124:125]
    v_pk_mul_f32 v[134:135], v[134:135], v[126:127]
    v_cvt_pk_bf16_f32 v252, v128, v129
    v_cvt_pk_bf16_f32 v253, v130, v131
    v_cvt_pk_bf16_f32 v254, v132, v133
    v_cvt_pk_bf16_f32 v255, v134, v135
    buffer_store_dwordx4 v[252:255], v27, s[52:55], s83 offen offset:3072 sc1
    s_waitcnt vmcnt(19)
    s_nop 0
    ds_write_b128 v22, v[40:43] offset:0
    s_add_u32 m0, s12, 7168
    s_add_u32 s13, s79, 21504
    buffer_load_dwordx4 v2, s[48:51], s13 offen lds
    v_alignbit_b32 v164, v41, v40, 16
    v_alignbit_b32 v165, v42, v41, 16
    v_alignbit_b32 v166, v43, v42, 16
    s_waitcnt vmcnt(19)
    v_alignbit_b32 v167, v44, v43, 16
    v_mov_b32 v168, v41
    v_mov_b32_e64 v169, v42
    v_mov_b32_e64 v170, v43
    v_mov_b32_e64 v171, v44
    v_alignbit_b32 v172, v42, v41, 16
    v_alignbit_b32 v173, v43, v42, 16
    v_alignbit_b32 v174, v44, v43, 16
    v_alignbit_b32 v175, v45, v44, 16
    s_add_u32 s13, s80, 35840
    buffer_load_dwordx4 a[120:123], v2, s[48:51], s13 offen
    s_waitcnt vmcnt(19)
    ds_write_b128 v22, v[46:49] offset:1024
    s_add_u32 s13, s80, 50176
    buffer_load_dwordx4 a[124:127], v2, s[48:51], s13 offen
    ds_write_b128 v22, v[164:167] offset:4160
    s_add_u32 s13, s81, 0
    buffer_load_dwordx4 a[128:131], v2, s[48:51], s13 offen
    ds_write_b128 v22, v[168:171] offset:8320
    s_add_u32 s13, s81, 14336
    buffer_load_dwordx4 a[132:135], v2, s[48:51], s13 offen
    ds_write_b128 v22, v[172:175] offset:12480
    s_add_u32 s13, s81, 7168
    buffer_load_dwordx4 a[136:139], v2, s[48:51], s13 offen
    v_alignbit_b32 v164, v47, v46, 16
    v_alignbit_b32 v165, v48, v47, 16
    v_alignbit_b32 v166, v49, v48, 16
    s_waitcnt vmcnt(22)
    v_alignbit_b32 v167, v50, v49, 16
    v_mov_b32 v168, v47
    v_mov_b32_e64 v169, v48
    v_mov_b32_e64 v170, v49
    v_mov_b32_e64 v171, v50
    v_alignbit_b32 v172, v48, v47, 16
    v_alignbit_b32 v173, v49, v48, 16
    v_alignbit_b32 v174, v50, v49, 16
    v_alignbit_b32 v175, v51, v50, 16
    s_add_u32 s13, s81, 21504
    buffer_load_dwordx4 a[140:143], v2, s[48:51], s13 offen
    s_cmp_eq_u32 s94, 1
    s_cbranch_scc1 KE_b
    ds_write_b128 v35, v[144:147] offset:512
    ds_write_b128 v37, v[160:163] offset:2048
    ds_write_b128 v37, v[160:163] offset:2048
    s_branch KE_j
KE_b:
    s_nop 0
    ds_write_b128 v35, v[148:151]
    ds_write_b128 v36, v[152:155] offset:256
    ds_write_b128 v36, v[156:159]
KE_j:
    s_add_u32 s13, s81, 28672
    buffer_load_dwordx4 a[144:147], v2, s[48:51], s13 offen
    ds_write_b128 v22, v[164:167] offset:5184
    s_add_u32 s13, s81, 43008
    buffer_load_dwordx4 a[148:151], v2, s[48:51], s13 offen
    ds_write_b128 v22, v[168:171] offset:9344
    s_add_u32 s13, s81, 35840
    buffer_load_dwordx4 a[152:155], v2, s[48:51], s13 offen
    ds_write_b128 v22, v[172:175] offset:13504
    s_add_u32 s13, s81, 50176
    buffer_load_dwordx4 a[156:159], v2, s[48:51], s13 offen
    s_waitcnt vmcnt(26)
    s_nop 0
    v_alignbit_b32 v176, v53, v52, v30
    v_alignbit_b32 v177, v54, v53, v30
    v_alignbit_b32 v178, v55, v54, v30
    v_alignbit_b32 v179, 0, v55, v30
    s_mov_b64 exec, 15
    ds_write_b128 v23, v[176:179]
    s_mov_b64 exec, -1
    s_waitcnt lgkmcnt(0)
    s_barrier
    ds_read_b64 v[64:65], v24 offset:0
    ds_read_b64 v[66:67], v24 offset:8
    ds_read_b128 v[128:131], v25 offset:1792
    ds_read_b128 v[132:135], v25 offset:1536
    ds_read_b128 v[136:139], v25 offset:1280
    ds_read_b128 v[140:143], v25 offset:1024
    ds_read_b128 v[144:147], v25 offset:768
    ds_read_b128 v[148:151], v25 offset:512
    ds_read_b128 v[152:155], v25 offset:256
    ds_read_b128 v[156:159], v25 offset:0
    ds_read_b64 v[68:69], v24 offset:512
    ds_read_b64 v[70:71], v24 offset:520
    s_waitcnt lgkmcnt(9)
    v_mfma_f32_16x16x32_bf16 v[192:195], v[64:67], v[128:131], 0
    ds_read_b64_tr_b16 a[224:225], v60 offset:16384
    ds_read_b64_tr_b16 a[226:227], v60 offset:16896
    ds_read_b64_tr_b16 a[228:229], v33 offset:16384
    ds_read_b64_tr_b16 a[230:231], v33 offset:16896
    s_waitcnt lgkmcnt(12)
    v_mfma_f32_16x16x32_bf16 v[196:199], v[64:67], v[132:135], 0
    ds_read_b64_tr_b16 a[232:233], v60 offset:0
    ds_read_b64_tr_b16 a[234:235], v60 offset:512
    ds_read_b64_tr_b16 a[236:237], v33 offset:0
    ds_read_b64_tr_b16 a[238:239], v33 offset:512
    s_waitcnt lgkmcnt(15)
    v_mfma_f32_16x16x32_bf16 v[200:203], v[64:67], v[136:139], 0
    ds_read_b64_tr_b16 a[240:241], v60 offset:2048
    ds_read_b64_tr_b16 a[242:243], v60 offset:2560
    ds_read_b64_tr_b16 a[244:245], v33 offset:2048
    ds_read_b64_tr_b16 a[246:247], v33 offset:2560
    s_waitcnt lgkmcnt(15)
    v_mfma_f32_16x16x32_bf16 v[204:207], v[64:67], v[140:143], 0
    ds_read_b64 v[72:73], v24 offset:1024
    v_mfma_f32_16x16x32_bf16 v[208:211], v[64:67], v[144:147], 0
    ds_read_b64 v[74:75], v24 offset:1032
    v_mfma_f32_16x16x32_bf16 v[212:215], v[64:67], v[148:151], 0
    ds_read_b64 v[76:77], v24 offset:1536
    v_mfma_f32_16x16x32_bf16 v[216:219], v[64:67], v[152:155], 0
    s_waitcnt vmcnt(11)
    v_mov_b32_e64 v62, s71
    s_mov_b64 exec, 1
    buffer_store_dword v62, off, s[52:55], s7 offset:64 sc1
    s_mov_b64 exec, -1
    s_waitcnt lgkmcnt(15)
    v_mfma_f32_16x16x32_bf16 v[220:223], v[64:67], v[156:159], 0
    ds_read_b64 v[78:79], v24 offset:1544
    v_mfma_f32_16x16x32_bf16 v[196:199], v[68:71], v[128:131], v[196:199]
    ds_read_b64 v[80:81], v24 offset:2048
    v_mfma_f32_16x16x32_bf16 v[200:203], v[68:71], v[132:135], v[200:203]
    s_waitcnt lgkmcnt(13)
    s_nop 0
    s_add_u32 m0, s72, 16384
    s_add_u32 s13, s79, 28672
    buffer_load_dwordx4 v2, s[48:51], s13 offen lds
    v_mfma_f32_16x16x32_bf16 v[204:207], v[68:71], v[136:139], v[204:207]
    ds_read_b64 v[82:83], v24 offset:2056
    v_mfma_f32_16x16x32_bf16 v[208:211], v[68:71], v[140:143], v[208:211]
    ds_read_b64 v[84:85], v24 offset:2560
    v_mfma_f32_16x16x32_bf16 v[212:215], v[68:71], v[144:147], v[212:215]
    ds_read_b64 v[86:87], v24 offset:2568
    v_mfma_f32_16x16x32_bf16 v[216:219], v[68:71], v[148:151], v[216:219]
    s_add_u32 m0, s72, 17408
    s_add_u32 s13, s79, 43008
    buffer_load_dwordx4 v2, s[48:51], s13 offen lds
    v_mfma_f32_16x16x32_bf16 v[220:223], v[68:71], v[152:155], v[220:223]
    ds_read_b64 v[88:89], v24 offset:3072
    s_waitcnt lgkmcnt(7)
    v_mfma_f32_16x16x32_bf16 v[200:203], v[72:75], v[128:131], v[200:203]
    ds_read_b64 v[90:91], v24 offset:3080
    v_mfma_f32_16x16x32_bf16 v[204:207], v[72:75], v[132:135], v[204:207]
    ds_read_b64 v[92:93], v24 offset:3584
    v_mfma_f32_16x16x32_bf16 v[208:211], v[72:75], v[136:139], v[208:211]
    s_add_u32 m0, s72, 0
    s_add_u32 s13, s79, 35840
    buffer_load_dwordx4 v2, s[48:51], s13 offen lds
    v_mfma_f32_16x16x32_bf16 v[212:215], v[72:75], v[140:143], v[212:215]
    ds_read_b64 v[94:95], v24 offset:3592
    v_mfma_f32_16x16x32_bf16 v[216:219], v[72:75], v[144:147], v[216:219]
    ds_read_b64 v[96:97], v24 offset:64
    v_mfma_f32_16x16x32_bf16 v[220:223], v[72:75], v[148:151], v[220:223]
    ds_read_b64 v[98:99], v24 offset:72
    s_waitcnt lgkmcnt(10)
    s_nop 0
    v_mfma_f32_16x16x32_bf16 v[204:207], v[76:79], v[128:131], v[204:207]
    s_add_u32 m0, s72, 1024
    s_add_u32 s13, s79, 50176
    buffer_load_dwordx4 v2, s[48:51], s13 offen lds
    v_mfma_f32_16x16x32_bf16 v[208:211], v[76:79], v[132:135], v[208:211]
    ds_read_b128 v[160:163], v25 offset:1824
    v_mfma_f32_16x16x32_bf16 v[212:215], v[76:79], v[136:139], v[212:215]
    ds_read_b128 v[164:167], v25 offset:1568
    v_mfma_f32_16x16x32_bf16 v[216:219], v[76:79], v[140:143], v[216:219]
    ds_read_b128 v[168:171], v25 offset:1312
    v_mfma_f32_16x16x32_bf16 v[220:223], v[76:79], v[144:147], v[220:223]
    s_add_u32 m0, s72, 2048
    s_add_u32 s13, s80, 0
    buffer_load_dwordx4 v2, s[48:51], s13 offen lds
    s_waitcnt lgkmcnt(11)
    v_mfma_f32_16x16x32_bf16 v[208:211], v[80:83], v[128:131], v[208:211]
    ds_read_b128 v[172:175], v25 offset:1056
    v_mfma_f32_16x16x32_bf16 v[212:215], v[80:83], v[132:135], v[212:215]
    ds_read_b128 v[176:179], v25 offset:800
    v_mfma_f32_16x16x32_bf16 v[216:219], v[80:83], v[136:139], v[216:219]
    ds_read_b128 v[180:183], v25 offset:544
    v_mfma_f32_16x16x32_bf16 v[220:223], v[80:83], v[140:143], v[220:223]
    s_add_u32 m0, s72, 3072
    s_add_u32 s13, s80, 14336
    buffer_load_dwordx4 v2, s[48:51], s13 offen lds
    s_waitcnt lgkmcnt(12)
    s_nop 0
    v_mfma_f32_16x16x32_bf16 v[212:215], v[84:87], v[128:131], v[212:215]
    ds_read_b128 v[184:187], v25 offset:288
    v_mfma_f32_16x16x32_bf16 v[216:219], v[84:87], v[132:135], v[216:219]
    ds_read_b128 v[188:191], v25 offset:32
    v_mfma_f32_16x16x32_bf16 v[220:223], v[84:87], v[136:139], v[220:223]
    ds_read_b64 v[100:101], v24 offset:576
    s_waitcnt lgkmcnt(13)
    v_mfma_f32_16x16x32_bf16 v[216:219], v[88:91], v[128:131], v[216:219]
    s_add_u32 s13, s82, 0
    buffer_load_dwordx4 a[160:163], v2, s[48:51], s13 offen
    v_mfma_f32_16x16x32_bf16 v[220:223], v[88:91], v[132:135], v[220:223]
    ds_read_b64_tr_b16 a[208:209], v60 offset:18432
    ds_read_b64_tr_b16 a[210:211], v60 offset:18944
    ds_read_b64_tr_b16 a[212:213], v33 offset:18432
    ds_read_b64_tr_b16 a[214:215], v33 offset:18944
    s_waitcnt lgkmcnt(15)
    v_mfma_f32_16x16x32_bf16 v[220:223], v[92:95], v[128:131], v[220:223]
    ds_read_b64 v[102:103], v24 offset:584
    s_waitcnt lgkmcnt(13)
    v_mfma_f32_16x16x32_bf16 v[192:195], v[96:99], v[160:163], v[192:195]
    ds_read_b64_tr_b16 a[216:217], v60 offset:4096
    ds_read_b64_tr_b16 a[218:219], v60 offset:4608
    ds_read_b64_tr_b16 a[220:221], v33 offset:4096
    ds_read_b64_tr_b16 a[222:223], v33 offset:4608
    s_waitcnt lgkmcnt(15)
    s_nop 0
    v_mfma_f32_16x16x32_bf16 v[196:199], v[96:99], v[164:167], v[196:199]
    s_add_u32 s13, s82, 14336
    buffer_load_dwordx4 a[164:167], v2, s[48:51], s13 offen
    v_mfma_f32_16x16x32_bf16 v[200:203], v[96:99], v[168:171], v[200:203]
    ds_read_b64 v[104:105], v24 offset:1088
    s_waitcnt lgkmcnt(15)
    v_mfma_f32_16x16x32_bf16 v[204:207], v[96:99], v[172:175], v[204:207]
    ds_read_b64 v[106:107], v24 offset:1096
    s_waitcnt lgkmcnt(15)
    v_mfma_f32_16x16x32_bf16 v[208:211], v[96:99], v[176:179], v[208:211]
    ds_read_b64 v[108:109], v24 offset:1600
    s_waitcnt lgkmcnt(15)
    v_mfma_f32_16x16x32_bf16 v[212:215], v[96:99], v[180:183], v[212:215]
    s_add_u32 s13, s82, 7168
    buffer_load_dwordx4 a[168:171], v2, s[48:51], s13 offen
    s_waitcnt lgkmcnt(14)
    v_mfma_f32_16x16x32_bf16 v[216:219], v[96:99], v[184:187], v[216:219]
    ds_read_b64 v[110:111], v24 offset:1608
    s_waitcnt lgkmcnt(14)
    v_mfma_f32_16x16x32_bf16 v[220:223], v[96:99], v[188:191], v[220:223]
    ds_read_b64 v[112:113], v24 offset:2112
    s_waitcnt lgkmcnt(9)
    v_mfma_f32_16x16x32_bf16 v[196:199], v[100:103], v[160:163], v[196:199]
    buffer_load_dword v18, v17, s[52:55], 0 offen offset:64 sc1
    v_mfma_f32_16x16x32_bf16 v[200:203], v[100:103], v[164:167], v[200:203]
    s_add_u32 m0, s72, 18432
    s_add_u32 s13, s80, 7168
    buffer_load_dwordx4 v2, s[48:51], s13 offen lds
    v_mfma_f32_16x16x32_bf16 v[204:207], v[100:103], v[168:171], v[204:207]
    ds_read_b64 v[114:115], v24 offset:2120
    v_mfma_f32_16x16x32_bf16 v[208:211], v[100:103], v[172:175], v[208:211]
    ds_read_b64 v[116:117], v24 offset:2624
    v_mfma_f32_16x16x32_bf16 v[212:215], v[100:103], v[176:179], v[212:215]
    ds_read_b64 v[118:119], v24 offset:2632
    v_mfma_f32_16x16x32_bf16 v[216:219], v[100:103], v[180:183], v[216:219]
    s_add_u32 m0, s72, 19456
    s_add_u32 s13, s80, 21504
    buffer_load_dwordx4 v2, s[48:51], s13 offen lds
    v_mfma_f32_16x16x32_bf16 v[220:223], v[100:103], v[184:187], v[220:223]
    ds_read_b64 v[120:121], v24 offset:3136
    s_waitcnt lgkmcnt(7)
    s_nop 0
    v_mfma_f32_16x16x32_bf16 v[200:203], v[104:107], v[160:163], v[200:203]
    ds_read_b64 v[122:123], v24 offset:3144
    v_mfma_f32_16x16x32_bf16 v[204:207], v[104:107], v[164:167], v[204:207]
    ds_read_b64 v[124:125], v24 offset:3648
    v_mfma_f32_16x16x32_bf16 v[208:211], v[104:107], v[168:171], v[208:211]
    s_add_u32 m0, s72, 4096
    s_add_u32 s13, s80, 28672
    buffer_load_dwordx4 v2, s[48:51], s13 offen lds
    v_mfma_f32_16x16x32_bf16 v[212:215], v[104:107], v[172:175], v[212:215]
    ds_read_b64 v[126:127], v24 offset:3656
    v_mfma_f32_16x16x32_bf16 v[216:219], v[104:107], v[176:179], v[216:219]
    ds_read_b64 v[64:65], v24 offset:128
    v_mfma_f32_16x16x32_bf16 v[220:223], v[104:107], v[180:183], v[220:223]
    ds_read_b64 v[66:67], v24 offset:136
    s_waitcnt lgkmcnt(10)
    s_nop 0
    v_mfma_f32_16x16x32_bf16 v[204:207], v[108:111], v[160:163], v[204:207]
    s_add_u32 m0, s72, 5120
    s_add_u32 s13, s80, 43008
    buffer_load_dwordx4 v2, s[48:51], s13 offen lds
    v_mfma_f32_16x16x32_bf16 v[208:211], v[108:111], v[164:167], v[208:211]
    ds_read_b128 v[128:131], v25 offset:1856
    v_mfma_f32_16x16x32_bf16 v[212:215], v[108:111], v[168:171], v[212:215]
    ds_read_b128 v[132:135], v25 offset:1600
    v_mfma_f32_16x16x32_bf16 v[216:219], v[108:111], v[172:175], v[216:219]
    ds_read_b128 v[136:139], v25 offset:1344
    v_mfma_f32_16x16x32_bf16 v[220:223], v[108:111], v[176:179], v[220:223]
    s_add_u32 s13, s82, 21504
    buffer_load_dwordx4 a[172:175], v2, s[48:51], s13 offen
    s_waitcnt lgkmcnt(11)
    s_nop 0
    v_mfma_f32_16x16x32_bf16 v[208:211], v[112:115], v[160:163], v[208:211]
    buffer_load_dword v16, v17, s[52:55], 0 offen offset:64 sc1
    v_mfma_f32_16x16x32_bf16 v[212:215], v[112:115], v[164:167], v[212:215]
    ds_read_b128 v[140:143], v25 offset:1088
    v_mfma_f32_16x16x32_bf16 v[216:219], v[112:115], v[168:171], v[216:219]
    ds_read_b128 v[144:147], v25 offset:832
    v_mfma_f32_16x16x32_bf16 v[220:223], v[112:115], v[172:175], v[220:223]
    s_add_u32 s13, s82, 28672
    buffer_load_dwordx4 a[176:179], v2, s[48:51], s13 offen
    s_waitcnt lgkmcnt(11)
    s_nop 0
    v_mfma_f32_16x16x32_bf16 v[212:215], v[116:119], v[160:163], v[212:215]
    ds_read_b128 v[148:151], v25 offset:576
    v_mfma_f32_16x16x32_bf16 v[216:219], v[116:119], v[164:167], v[216:219]
    ds_read_b128 v[152:155], v25 offset:320
    v_mfma_f32_16x16x32_bf16 v[220:223], v[116:119], v[168:171], v[220:223]
    ds_read_b128 v[156:159], v25 offset:64
    s_waitcnt lgkmcnt(12)
    v_mfma_f32_16x16x32_bf16 v[216:219], v[120:123], v[160:163], v[216:219]
    s_add_u32 s13, s82, 43008
    buffer_load_dwordx4 a[180:183], v2, s[48:51], s13 offen
    v_mfma_f32_16x16x32_bf16 v[220:223], v[120:123], v[164:167], v[220:223]
    ds_read_b64 v[68:69], v24 offset:640
    s_waitcnt lgkmcnt(11)
    v_mfma_f32_16x16x32_bf16 v[220:223], v[124:127], v[160:163], v[220:223]
    ds_read_b64 v[70:71], v24 offset:648
    s_waitcnt lgkmcnt(9)
    v_mfma_f32_16x16x32_bf16 v[192:195], v[64:67], v[128:131], v[192:195]
    ds_read_b64 v[72:73], v24 offset:1152
    s_waitcnt lgkmcnt(9)
    v_mfma_f32_16x16x32_bf16 v[196:199], v[64:67], v[132:135], v[196:199]
    s_add_u32 s13, s82, 35840
    buffer_load_dwordx4 a[184:187], v2, s[48:51], s13 offen
    s_waitcnt lgkmcnt(8)
    v_mfma_f32_16x16x32_bf16 v[200:203], v[64:67], v[136:139], v[200:203]
    ds_read_b64 v[74:75], v24 offset:1160
    s_waitcnt lgkmcnt(8)
    v_mfma_f32_16x16x32_bf16 v[204:207], v[64:67], v[140:143], v[204:207]
    ds_read_b64 v[76:77], v24 offset:1664
    s_waitcnt lgkmcnt(8)
    v_mfma_f32_16x16x32_bf16 v[208:211], v[64:67], v[144:147], v[208:211]
    ds_read_b64 v[78:79], v24 offset:1672
    s_waitcnt lgkmcnt(8)
    v_mfma_f32_16x16x32_bf16 v[212:215], v[64:67], v[148:151], v[212:215]
    s_add_u32 s13, s82, 50176
    buffer_load_dwordx4 a[188:191], v2, s[48:51], s13 offen
    s_waitcnt lgkmcnt(7)
    v_mfma_f32_16x16x32_bf16 v[216:219], v[64:67], v[152:155], v[216:219]
    ds_read_b64 v[80:81], v24 offset:2176
    s_waitcnt lgkmcnt(7)
    v_mfma_f32_16x16x32_bf16 v[220:223], v[64:67], v[156:159], v[220:223]
    ds_read_b64 v[82:83], v24 offset:2184
    s_waitcnt lgkmcnt(6)
    v_mfma_f32_16x16x32_bf16 v[196:199], v[68:71], v[128:131], v[196:199]
    s_waitcnt vmcnt(10)
    v_cmp_ne_u32 vcc, s71, v18
    s_nop 0
    s_and_b64 vcc, vcc, exec
    s_nop 3
    s_cbranch_scc0 P3_ok
    s_waitcnt vmcnt(4)
    v_cmp_ne_u32 vcc, s71, v16
    s_nop 0
    s_and_b64 vcc, vcc, exec
    s_cbranch_scc0 P3_ok
    s_mov_b32 s99, 0x40000
P3_lp:
    buffer_load_dword v18, v17, s[52:55], 0 offen offset:64 sc1
    s_waitcnt vmcnt(0)
    s_sub_u32 s99, s99, 1
    s_cbranch_scc1 P3_ok
    v_cmp_ne_u32_e64 vcc, s71, v18
    s_nop 0
    s_and_b64 vcc, vcc, exec
    s_cbranch_scc1 P3_lp
P3_ok:
    v_mfma_f32_16x16x32_bf16 v[200:203], v[68:71], v[132:135], v[200:203]
    buffer_load_dwordx4 a[0:3], v13, s[52:55], s84 offen offset:0 sc1
    v_mfma_f32_16x16x32_bf16 v[204:207], v[68:71], v[136:139], v[204:207]
    ds_read_b64 v[84:85], v24 offset:2688
    v_mfma_f32_16x16x32_bf16 v[208:211], v[68:71], v[140:143], v[208:211]
    ds_read_b64 v[86:87], v24 offset:2696
    v_mfma_f32_16x16x32_bf16 v[212:215], v[68:71], v[144:147], v[212:215]
    ds_read_b64 v[88:89], v24 offset:3200
    v_mfma_f32_16x16x32_bf16 v[216:219], v[68:71], v[148:151], v[216:219]
    ds_read_b64 v[90:91], v24 offset:3208
    v_mfma_f32_16x16x32_bf16 v[220:223], v[68:71], v[152:155], v[220:223]
    buffer_load_dwordx4 a[4:7], v13, s[52:55], s84 offen offset:1024 sc1
    s_waitcnt lgkmcnt(8)
    s_nop 0
    v_mfma_f32_16x16x32_bf16 v[200:203], v[72:75], v[128:131], v[200:203]
    ds_read_b64 v[92:93], v24 offset:3712
    v_mfma_f32_16x16x32_bf16 v[204:207], v[72:75], v[132:135], v[204:207]
    ds_read_b64 v[94:95], v24 offset:3720
    v_mfma_f32_16x16x32_bf16 v[208:211], v[72:75], v[136:139], v[208:211]
    ds_read_b64 v[96:97], v24 offset:192
    v_mfma_f32_16x16x32_bf16 v[212:215], v[72:75], v[140:143], v[212:215]
    ds_read_b64 v[98:99], v24 offset:200
    v_mfma_f32_16x16x32_bf16 v[216:219], v[72:75], v[144:147], v[216:219]
    buffer_load_dwordx4 a[8:11], v13, s[52:55], s84 offen offset:2048 sc1
    v_mfma_f32_16x16x32_bf16 v[220:223], v[72:75], v[148:151], v[220:223]
    ds_read_b128 v[160:163], v25 offset:1888
    s_waitcnt lgkmcnt(11)
    s_nop 0
    v_mfma_f32_16x16x32_bf16 v[204:207], v[76:79], v[128:131], v[204:207]
    ds_read_b128 v[164:167], v25 offset:1632
    v_mfma_f32_16x16x32_bf16 v[208:211], v[76:79], v[132:135], v[208:211]
    ds_read_b128 v[168:171], v25 offset:1376
    v_mfma_f32_16x16x32_bf16 v[212:215], v[76:79], v[136:139], v[212:215]
    ds_read_b128 v[172:175], v25 offset:1120
    v_mfma_f32_16x16x32_bf16 v[216:219], v[76:79], v[140:143], v[216:219]
    buffer_load_dwordx4 a[12:15], v13, s[52:55], s84 offen offset:3072 sc1
    v_mfma_f32_16x16x32_bf16 v[220:223], v[76:79], v[144:147], v[220:223]
    ds_read_b128 v[176:179], v25 offset:864
    s_waitcnt lgkmcnt(13)
    s_nop 0
    v_mfma_f32_16x16x32_bf16 v[208:211], v[80:83], v[128:131], v[208:211]
    ds_read_b128 v[180:183], v25 offset:608
    v_mfma_f32_16x16x32_bf16 v[212:215], v[80:83], v[132:135], v[212:215]
    ds_read_b128 v[184:187], v25 offset:352
    v_mfma_f32_16x16x32_bf16 v[216:219], v[80:83], v[136:139], v[216:219]
    ds_read_b128 v[188:191], v25 offset:96
    v_mfma_f32_16x16x32_bf16 v[220:223], v[80:83], v[140:143], v[220:223]
    buffer_load_dwordx4 a[16:19], v27, s[52:55], s84 offen offset:0 sc1
    s_waitcnt lgkmcnt(14)
    v_mfma_f32_16x16x32_bf16 v[212:215], v[84:87], v[128:131], v[212:215]
    ds_read_b64 v[100:101], v24 offset:704
    v_mfma_f32_16x16x32_bf16 v[216:219], v[84:87], v[132:135], v[216:219]
    ds_read_b64 v[102:103], v24 offset:712
    v_mfma_f32_16x16x32_bf16 v[220:223], v[84:87], v[136:139], v[220:223]
    ds_read_b64 v[104:105], v24 offset:1216
    s_waitcnt lgkmcnt(15)
    v_mfma_f32_16x16x32_bf16 v[216:219], v[88:91], v[128:131], v[216:219]
    ds_read_b64 v[106:107], v24 offset:1224
    v_mfma_f32_16x16x32_bf16 v[220:223], v[88:91], v[132:135], v[220:223]
    buffer_load_dwordx4 a[20:23], v27, s[52:55], s84 offen offset:1024 sc1
    s_waitcnt lgkmcnt(14)
    v_mfma_f32_16x16x32_bf16 v[220:223], v[92:95], v[128:131], v[220:223]
    ds_read_b64 v[108:109], v24 offset:1728
    s_waitcnt lgkmcnt(12)
    v_mfma_f32_16x16x32_bf16 v[192:195], v[96:99], v[160:163], v[192:195]
    ds_read_b64 v[110:111], v24 offset:1736
    s_waitcnt lgkmcnt(12)
    v_mfma_f32_16x16x32_bf16 v[196:199], v[96:99], v[164:167], v[196:199]
    ds_read_b64 v[112:113], v24 offset:2240
    s_waitcnt lgkmcnt(12)
    v_mfma_f32_16x16x32_bf16 v[200:203], v[96:99], v[168:171], v[200:203]
    ds_read_b64 v[114:115], v24 offset:2248
    s_waitcnt lgkmcnt(12)
    v_mfma_f32_16x16x32_bf16 v[204:207], v[96:99], v[172:175], v[204:207]
    buffer_load_dwordx4 a[24:27], v27, s[52:55], s84 offen offset:2048 sc1
    s_waitcnt lgkmcnt(11)
    v_mfma_f32_16x16x32_bf16 v[208:211], v[96:99], v[176:179], v[208:211]
    ds_read_b64 v[116:117], v24 offset:2752
    s_waitcnt lgkmcnt(11)
    v_mfma_f32_16x16x32_bf16 v[212:215], v[96:99], v[180:183], v[212:215]
    ds_read_b64 v[118:119], v24 offset:2760
    s_waitcnt lgkmcnt(11)
    v_mfma_f32_16x16x32_bf16 v[216:219], v[96:99], v[184:187], v[216:219]
    ds_read_b64 v[120:121], v24 offset:3264
    s_waitcnt lgkmcnt(11)
    v_mfma_f32_16x16x32_bf16 v[220:223], v[96:99], v[188:191], v[220:223]
    ds_read_b64 v[122:123], v24 offset:3272
    s_waitcnt lgkmcnt(10)
    v_mfma_f32_16x16x32_bf16 v[196:199], v[100:103], v[160:163], v[196:199]
    buffer_load_dwordx4 a[28:31], v27, s[52:55], s84 offen offset:3072 sc1
    v_mfma_f32_16x16x32_bf16 v[200:203], v[100:103], v[164:167], v[200:203]
    ds_read_b64 v[124:125], v24 offset:3776
    v_mfma_f32_16x16x32_bf16 v[204:207], v[100:103], v[168:171], v[204:207]
    ds_read_b64 v[126:127], v24 offset:3784
    v_mfma_f32_16x16x32_bf16 v[208:211], v[100:103], v[172:175], v[208:211]
    v_mfma_f32_16x16x32_bf16 v[212:215], v[100:103], v[176:179], v[212:215]
    v_mfma_f32_16x16x32_bf16 v[216:219], v[100:103], v[180:183], v[216:219]
    buffer_load_dwordx4 a[32:35], v13, s[52:55], s85 offen offset:0 sc1
    v_mfma_f32_16x16x32_bf16 v[220:223], v[100:103], v[184:187], v[220:223]
    s_waitcnt lgkmcnt(10)
    v_mfma_f32_16x16x32_bf16 v[200:203], v[104:107], v[160:163], v[200:203]
    v_mfma_f32_16x16x32_bf16 v[204:207], v[104:107], v[164:167], v[204:207]
    v_mfma_f32_16x16x32_bf16 v[208:211], v[104:107], v[168:171], v[208:211]
    v_mfma_f32_16x16x32_bf16 v[212:215], v[104:107], v[172:175], v[212:215]
    buffer_load_dwordx4 a[36:39], v13, s[52:55], s85 offen offset:1024 sc1
    v_mfma_f32_16x16x32_bf16 v[216:219], v[104:107], v[176:179], v[216:219]
    v_mfma_f32_16x16x32_bf16 v[220:223], v[104:107], v[180:183], v[220:223]
    s_waitcnt lgkmcnt(8)
    v_mfma_f32_16x16x32_bf16 v[204:207], v[108:111], v[160:163], v[204:207]
    v_mfma_f32_16x16x32_bf16 v[208:211], v[108:111], v[164:167], v[208:211]
    v_mfma_f32_16x16x32_bf16 v[212:215], v[108:111], v[168:171], v[212:215]
    buffer_load_dwordx4 a[40:43], v13, s[52:55], s85 offen offset:2048 sc1
    v_mfma_f32_16x16x32_bf16 v[216:219], v[108:111], v[172:175], v[216:219]
    v_mfma_f32_16x16x32_bf16 v[220:223], v[108:111], v[176:179], v[220:223]
    s_waitcnt lgkmcnt(6)
    v_mfma_f32_16x16x32_bf16 v[208:211], v[112:115], v[160:163], v[208:211]
    v_mfma_f32_16x16x32_bf16 v[212:215], v[112:115], v[164:167], v[212:215]
    v_mfma_f32_16x16x32_bf16 v[216:219], v[112:115], v[168:171], v[216:219]
    buffer_load_dwordx4 a[44:47], v13, s[52:55], s85 offen offset:3072 sc1
    v_mfma_f32_16x16x32_bf16 v[220:223], v[112:115], v[172:175], v[220:223]
    s_waitcnt lgkmcnt(4)
    v_mfma_f32_16x16x32_bf16 v[212:215], v[116:119], v[160:163], v[212:215]
    v_mfma_f32_16x16x32_bf16 v[216:219], v[116:119], v[164:167], v[216:219]
    v_mfma_f32_16x16x32_bf16 v[220:223], v[116:119], v[168:171], v[220:223]
    s_waitcnt lgkmcnt(2)
    v_mfma_f32_16x16x32_bf16 v[216:219], v[120:123], v[160:163], v[216:219]
    buffer_load_dwordx4 a[48:51], v27, s[52:55], s85 offen offset:0 sc1
    v_mfma_f32_16x16x32_bf16 v[220:223], v[120:123], v[164:167], v[220:223]
    s_waitcnt lgkmcnt(0)
    v_mfma_f32_16x16x32_bf16 v[220:223], v[124:127], v[160:163], v[220:223]
    s_barrier
    s_cmp_eq_u32 s94, 1
    s_nop 5
    s_cbranch_scc1 CS0_b
    ds_write_b128 v28, v[208:211] offset:0
    ds_write_b128 v28, v[212:215] offset:1024
    s_branch CS0_j
CS0_b:
    ds_write_b128 v28, v[192:195] offset:0
    ds_write_b128 v28, v[196:199] offset:1024
CS0_j:
    s_cmp_eq_u32 s94, 1
    s_cbranch_scc1 CS1_b
    ds_write_b128 v28, v[216:219] offset:2048
    ds_write_b128 v28, v[220:223] offset:3072
    s_branch CS1_j
CS1_b:
    ds_write_b128 v28, v[200:203] offset:2048
    ds_write_b128 v28, v[204:207] offset:3072
CS1_j:
    v_mfma_f32_32x32x16_bf16 v[64:79], a[224:227], v[224:227], 0
    buffer_load_dwordx4 a[52:55], v27, s[52:55], s85 offen offset:1024 sc1
    v_mfma_f32_32x32x16_bf16 v[80:95], a[228:231], v[224:227], 0
    buffer_load_dwordx4 a[56:59], v27, s[52:55], s85 offen offset:2048 sc1
    v_mfma_f32_32x32x16_bf16 v[96:111], a[224:227], v[240:243], 0
    s_waitcnt lgkmcnt(0)
    s_barrier
    ds_read_b128 v[128:131], v29 offset:0
    ds_read_b128 v[132:135], v29 offset:1024
    ds_read_b128 v[136:139], v29 offset:2048
    ds_read_b128 v[140:143], v29 offset:3072
    v_mfma_f32_32x32x16_bf16 v[112:127], a[228:231], v[240:243], 0
    buffer_load_dwordx4 a[60:63], v27, s[52:55], s85 offen offset:3072 sc1
    v_mfma_f32_32x32x16_bf16 v[64:79], a[232:235], v[228:231], v[64:79]
    buffer_load_dwordx4 a[64:67], v13, s[52:55], s86 offen offset:0 sc1
    v_mfma_f32_32x32x16_bf16 v[80:95], a[236:239], v[228:231], v[80:95]
    buffer_load_dwordx4 a[68:71], v13, s[52:55], s86 offen offset:1024 sc1
    v_mfma_f32_32x32x16_bf16 v[96:111], a[232:235], v[244:247], v[96:111]
    buffer_load_dwordx4 a[72:75], v13, s[52:55], s86 offen offset:2048 sc1
    s_cmp_eq_u32 s94, 1
    s_waitcnt lgkmcnt(3)
    s_cbranch_scc1 CA0_b
    v_add_f32 v128, v128, v192
    v_add_f32_e64 v129, v129, v193
    v_add_f32_e64 v130, v130, v194
    v_add_f32 v131, v131, v195
    s_branch CA0_j
CA0_b:
    v_add_f32_e64 v128, v128, v208
    v_add_f32_e64 v129, v129, v209
    v_add_f32_e64 v130, v130, v210
    v_add_f32_e64 v131, v131, v211
CA0_j:
    v_mfma_f32_32x32x16_bf16 v[112:127], a[236:239], v[244:247], v[112:127]
    s_cmp_eq_u32 s94, 1
    s_waitcnt lgkmcnt(2)
    s_cbranch_scc1 CA1_b
    v_add_f32 v132, v132, v196
    v_add_f32_e64 v133, v133, v197
    v_add_f32_e64 v134, v134, v198
    v_add_f32 v135, v135, v199
    s_branch CA1_j
CA1_b:
    v_add_f32_e64 v132, v132, v212
    v_add_f32_e64 v133, v133, v213
    v_add_f32_e64 v134, v134, v214
    v_add_f32_e64 v135, v135, v215
CA1_j:
    v_mfma_f32_32x32x16_bf16 v[64:79], a[240:243], v[232:235], v[64:79]
    buffer_load_dwordx4 a[76:79], v13, s[52:55], s86 offen offset:3072 sc1
    s_cmp_eq_u32 s94, 1
    s_waitcnt lgkmcnt(1)
    s_cbranch_scc1 CA2_b
    v_add_f32 v136, v136, v200
    v_add_f32_e64 v137, v137, v201
    v_add_f32_e64 v138, v138, v202
    v_add_f32 v139, v139, v203
    s_branch CA2_j
CA2_b:
    v_add_f32_e64 v136, v136, v216
    v_add_f32_e64 v137, v137, v217
    v_add_f32_e64 v138, v138, v218
    v_add_f32_e64 v139, v139, v219
CA2_j:
    v_mfma_f32_32x32x16_bf16 v[80:95], a[244:247], v[232:235], v[80:95]
    s_cmp_eq_u32 s94, 1
    s_waitcnt lgkmcnt(0)
    s_cbranch_scc1 CA3_b
    v_add_f32 v140, v140, v204
    v_add_f32_e64 v141, v141, v205
    v_add_f32_e64 v142, v142, v206
    v_add_f32 v143, v143, v207
    s_branch CA3_j
CA3_b:
    v_add_f32_e64 v140, v140, v220
    v_add_f32_e64 v141, v141, v221
    v_add_f32_e64 v142, v142, v222
    v_add_f32_e64 v143, v143, v223
CA3_j:
    v_mfma_f32_32x32x16_bf16 v[96:111], a[240:243], v[248:251], v[96:111]
    buffer_load_dwordx4 a[80:83], v27, s[52:55], s86 offen offset:0 sc1
    v_cvt_pk_bf16_f32 v160, v128, v129
    v_cvt_pk_bf16_f32 v161, v130, v131
    v_cvt_pk_bf16_f32 v162, v132, v133
    v_cvt_pk_bf16_f32 v163, v134, v135
    v_mfma_f32_32x32x16_bf16 v[112:127], a[244:247], v[248:251], v[112:127]
    v_cvt_pk_bf16_f32 v164, v136, v137
    v_cvt_pk_bf16_f32 v165, v138, v139
    v_cvt_pk_bf16_f32 v166, v140, v141
    v_cvt_pk_bf16_f32 v167, v142, v143
    v_mfma_f32_32x32x16_bf16 v[64:79], a[208:211], v[236:239], v[64:79]
    ds_read_b64_tr_b16 a[240:241], v60 offset:6144
    ds_read_b64_tr_b16 a[242:243], v60 offset:6656
    buffer_load_dwordx4 a[84:87], v27, s[52:55], s86 offen offset:1024 sc1
    v_permlane16_swap_b32 v160, v162
    v_permlane16_swap_b32 v161, v163
    v_permlane16_swap_b32 v164, v166
    v_permlane16_swap_b32 v165, v167
    v_mfma_f32_32x32x16_bf16 v[80:95], a[212:215], v[236:239], v[80:95]
    ds_read_b64_tr_b16 a[244:245], v33 offset:6144
    ds_read_b64_tr_b16 a[246:247], v33 offset:6656
    buffer_store_dwordx4 v[160:163], v26, s[52:55], s8 offen offset:0 sc1
    v_mfma_f32_32x32x16_bf16 v[96:111], a[208:211], v[252:255], v[96:111]
    buffer_store_dwordx4 v[164:167], v26, s[52:55], s8 offen offset:1024 sc1
    v_mfma_f32_32x32x16_bf16 v[112:127], a[212:215], v[252:255], v[112:127]
    ds_write_b128 v8, a[120:123] offset:6144
    s_waitcnt vmcnt(23)
    s_nop 0
    v_mfma_f32_32x32x16_bf16 v[64:79], a[216:219], a[0:3], v[64:79]
    ds_read_b64_tr_b16 a[224:225], v60 offset:8192
    ds_read_b64_tr_b16 a[226:227], v60 offset:8704
    buffer_load_dwordx4 a[88:91], v27, s[52:55], s86 offen offset:2048 sc1
    v_mfma_f32_32x32x16_bf16 v[80:95], a[220:223], a[0:3], v[80:95]
    ds_read_b64_tr_b16 a[228:229], v33 offset:8192
    ds_read_b64_tr_b16 a[230:231], v33 offset:8704
    s_waitcnt vmcnt(20)
    v_mfma_f32_32x32x16_bf16 v[96:111], a[216:219], a[16:19], v[96:111]
    buffer_load_dwordx4 a[92:95], v27, s[52:55], s86 offen offset:3072 sc1
    v_mfma_f32_32x32x16_bf16 v[112:127], a[220:223], a[16:19], v[112:127]
    ds_write_b128 v8, a[124:127] offset:7168
    s_waitcnt lgkmcnt(8)
    v_mfma_f32_32x32x16_bf16 v[64:79], a[240:243], a[4:7], v[64:79]
    ds_read_b64_tr_b16 a[232:233], v60 offset:10240
    ds_read_b64_tr_b16 a[234:235], v60 offset:10752
    buffer_load_dwordx4 a[96:99], v13, s[52:55], s87 offen offset:0 sc1
    s_waitcnt lgkmcnt(8)
    v_mfma_f32_32x32x16_bf16 v[80:95], a[244:247], a[4:7], v[80:95]
    ds_read_b64_tr_b16 a[236:237], v33 offset:10240
    ds_read_b64_tr_b16 a[238:239], v33 offset:10752
    s_waitcnt vmcnt(21)
    v_mfma_f32_32x32x16_bf16 v[96:111], a[240:243], a[20:23], v[96:111]
    buffer_load_dwordx4 a[100:103], v13, s[52:55], s87 offen offset:1024 sc1
    v_mfma_f32_32x32x16_bf16 v[112:127], a[244:247], a[20:23], v[112:127]
    ds_write_b128 v8, a[128:131] offset:8192
    s_waitcnt lgkmcnt(8)
    v_mfma_f32_32x32x16_bf16 v[64:79], a[224:227], a[8:11], v[64:79]
    ds_read_b64_tr_b16 a[240:241], v60 offset:12288
    ds_read_b64_tr_b16 a[242:243], v60 offset:12800
    buffer_load_dwordx4 a[104:107], v13, s[52:55], s87 offen offset:2048 sc1
    s_waitcnt lgkmcnt(8)
    v_mfma_f32_32x32x16_bf16 v[80:95], a[228:231], a[8:11], v[80:95]
    ds_read_b64_tr_b16 a[244:245], v33 offset:12288
    ds_read_b64_tr_b16 a[246:247], v33 offset:12800
    s_lshl_b32 s75, s68, 1
    s_add_u32 s75, s75, s94
    s_lshl_b32 s74, s69, 1
    s_add_u32 s74, s74, s95
    s_waitcnt vmcnt(22)
    v_mfma_f32_32x32x16_bf16 v[96:111], a[224:227], a[24:27], v[96:111]
    buffer_load_dwordx4 a[108:111], v13, s[52:55], s87 offen offset:3072 sc1
    v_mfma_f32_32x32x16_bf16 v[112:127], a[228:231], a[24:27], v[112:127]
    ds_write_b128 v8, a[132:135] offset:9216
    s_waitcnt lgkmcnt(8)
    v_mfma_f32_32x32x16_bf16 v[64:79], a[232:235], a[12:15], v[64:79]
    ds_read_b64_tr_b16 a[224:225], v60 offset:14336
    ds_read_b64_tr_b16 a[226:227], v60 offset:14848
    buffer_load_dwordx4 a[112:115], v27, s[52:55], s87 offen offset:0 sc1
    s_waitcnt lgkmcnt(8)
    v_mfma_f32_32x32x16_bf16 v[80:95], a[236:239], a[12:15], v[80:95]
    ds_read_b64_tr_b16 a[228:229], v33 offset:14336
    ds_read_b64_tr_b16 a[230:231], v33 offset:14848
    s_mul_i32 s92, s74, 28672
    s_lshl_b32 s90, s75, 6
    s_add_u32 s92, s92, s90
    s_waitcnt vmcnt(23)
    v_mfma_f32_32x32x16_bf16 v[96:111], a[232:235], a[28:31], v[96:111]
    buffer_load_dwordx4 a[116:119], v27, s[52:55], s87 offen offset:1024 sc1
    v_mfma_f32_32x32x16_bf16 v[112:127], a[236:239], a[28:31], v[112:127]
    ds_write_b128 v8, a[136:139] offset:10240
    s_waitcnt vmcnt(23) lgkmcnt(8)
    v_mfma_f32_32x32x16_bf16 v[64:79], a[240:243], a[32:35], v[64:79]
    ds_read_b64_tr_b16 a[232:233], v31 offset:0
    ds_read_b64_tr_b16 a[234:235], v31 offset:512
    buffer_load_dwordx4 a[120:123], v27, s[52:55], s87 offen offset:2048 sc1
    s_waitcnt lgkmcnt(8)
    v_mfma_f32_32x32x16_bf16 v[80:95], a[244:247], a[32:35], v[80:95]
    ds_read_b64_tr_b16 a[236:237], v32 offset:0
    ds_read_b64_tr_b16 a[238:239], v32 offset:512
    v_and_b32 v16, 31, v0
    v_mul_u32_u24 v16, 896, v16
    v_lshl_add_u32 v16, v56, 5, v16
    s_waitcnt vmcnt(20)
    v_mfma_f32_32x32x16_bf16 v[96:111], a[240:243], a[48:51], v[96:111]
    buffer_load_dwordx4 a[124:127], v27, s[52:55], s87 offen offset:3072 sc1
    v_mfma_f32_32x32x16_bf16 v[112:127], a[244:247], a[48:51], v[112:127]
    ds_write_b128 v8, a[140:143] offset:11264
    s_waitcnt lgkmcnt(8)
    v_mfma_f32_32x32x16_bf16 v[64:79], a[224:227], a[36:39], v[64:79]
    ds_read_b64_tr_b16 a[240:241], v31 offset:2048
    ds_read_b64_tr_b16 a[242:243], v31 offset:2560
    buffer_load_dwordx4 a[128:131], v13, s[52:55], s88 offen offset:0 sc1
    s_waitcnt lgkmcnt(8)
    v_mfma_f32_32x32x16_bf16 v[80:95], a[228:231], a[36:39], v[80:95]
    ds_read_b64_tr_b16 a[244:245], v32 offset:2048
    ds_read_b64_tr_b16 a[246:247], v32 offset:2560
    v_lshl_add_u32 v19, v56, 5, s90
    s_lshl_b32 s90, s75, 10
    s_add_u32 s90, s90, 11796480
    v_lshl_add_u32 v15, v0, 4, s90
    s_waitcnt vmcnt(21)
    v_mfma_f32_32x32x16_bf16 v[96:111], a[224:227], a[52:55], v[96:111]
    buffer_load_dwordx4 a[132:135], v13, s[52:55], s88 offen offset:1024 sc1
    v_mfma_f32_32x32x16_bf16 v[112:127], a[228:231], a[52:55], v[112:127]
    ds_write_b128 v8, a[144:147] offset:12288
    s_waitcnt lgkmcnt(8)
    v_mfma_f32_32x32x16_bf16 v[64:79], a[232:235], a[40:43], v[64:79]
    ds_read_b64_tr_b16 a[224:225], v31 offset:4096
    ds_read_b64_tr_b16 a[226:227], v31 offset:4608
    buffer_load_dwordx4 a[136:139], v13, s[52:55], s88 offen offset:2048 sc1
    s_waitcnt lgkmcnt(8)
    v_mfma_f32_32x32x16_bf16 v[80:95], a[236:239], a[40:43], v[80:95]
    ds_read_b64_tr_b16 a[228:229], v32 offset:4096
    ds_read_b64_tr_b16 a[230:231], v32 offset:4608
    s_waitcnt vmcnt(13)
    v_mov_b32_e64 v62, s71
    s_mov_b64 exec, 1
    buffer_store_dword v62, off, s[52:55], s10 offset:0 sc1
    s_mov_b64 exec, -1
    s_lshl_b32 s75, s75, 17
    s_lshl_b32 s90, s74, 6
    s_add_u32 s75, s75, s90
    s_add_u32 s75, s75, 2097152
    v_mfma_f32_32x32x16_bf16 v[96:111], a[232:235], a[56:59], v[96:111]
    buffer_load_dwordx4 a[140:143], v13, s[52:55], s88 offen offset:3072 sc1
    v_mfma_f32_32x32x16_bf16 v[112:127], a[236:239], a[56:59], v[112:127]
    ds_write_b128 v8, a[148:151] offset:13312
    s_waitcnt lgkmcnt(8)
    v_mfma_f32_32x32x16_bf16 v[64:79], a[240:243], a[44:47], v[64:79]
    ds_read_b64_tr_b16 a[232:233], v31 offset:6144
    ds_read_b64_tr_b16 a[234:235], v31 offset:6656
    buffer_load_dwordx4 a[144:147], v27, s[52:55], s88 offen offset:0 sc1
    s_waitcnt lgkmcnt(8)
    v_mfma_f32_32x32x16_bf16 v[80:95], a[244:247], a[44:47], v[80:95]
    ds_read_b64_tr_b16 a[236:237], v32 offset:6144
    ds_read_b64_tr_b16 a[238:239], v32 offset:6656
    v_lshrrev_b32_e64 v20, 2, v0
    v_lshlrev_b32_e64 v20, 12, v20
    v_and_b32_e64 v21, 3, v0
    v_lshl_add_u32 v20, v21, 4, v20
    v_mfma_f32_32x32x16_bf16 v[96:111], a[240:243], a[60:63], v[96:111]
    buffer_load_dwordx4 a[148:151], v27, s[52:55], s88 offen offset:1024 sc1
    v_mfma_f32_32x32x16_bf16 v[112:127], a[244:247], a[60:63], v[112:127]
    ds_write_b128 v8, a[152:155] offset:14336
    s_waitcnt lgkmcnt(8)
    v_mfma_f32_32x32x16_bf16 v[64:79], a[224:227], a[64:67], v[64:79]
    ds_read_b64_tr_b16 a[240:241], v60 offset:16384
    ds_read_b64_tr_b16 a[242:243], v60 offset:16896
    buffer_load_dwordx4 a[152:155], v27, s[52:55], s88 offen offset:2048 sc1
    s_waitcnt lgkmcnt(8)
    v_mfma_f32_32x32x16_bf16 v[80:95], a[228:231], a[64:67], v[80:95]
    ds_read_b64_tr_b16 a[244:245], v33 offset:16384
    ds_read_b64_tr_b16 a[246:247], v33 offset:16896
    s_lshl_b32 s90, s70, 11
    s_add_u32 s90, s90, 69888
    v_add_u32 v21, s90, v13
    v_mfma_f32_32x32x16_bf16 v[96:111], a[224:227], a[80:83], v[96:111]
    buffer_load_dwordx4 a[208:211], v13, s[52:55], s89 offen offset:2048 sc1
    v_mfma_f32_32x32x16_bf16 v[112:127], a[228:231], a[80:83], v[112:127]
    ds_write_b128 v8, a[156:159] offset:15360
    s_waitcnt lgkmcnt(8)
    v_mfma_f32_32x32x16_bf16 v[64:79], a[232:235], a[68:71], v[64:79]
    ds_read_b64_tr_b16 a[224:225], v60 offset:0
    ds_read_b64_tr_b16 a[226:227], v60 offset:512
    buffer_load_dwordx4 a[156:159], v27, s[52:55], s88 offen offset:3072 sc1
    s_waitcnt lgkmcnt(8)
    v_mfma_f32_32x32x16_bf16 v[80:95], a[236:239], a[68:71], v[80:95]
    ds_read_b64_tr_b16 a[228:229], v33 offset:0
    ds_read_b64_tr_b16 a[230:231], v33 offset:512
    v_bfe_u32 v22, v0, 2, 2
    v_lshl_add_u32 v22, v56, 4, v22
    v_lshl_add_u32 v22, v22, 6, v61
    v_add_u32_e64 v22, s90, v22
    v_mfma_f32_32x32x16_bf16 v[96:111], a[232:235], a[84:87], v[96:111]
    buffer_load_dwordx4 a[212:215], v13, s[52:55], s89 offen offset:3072 sc1
    v_mfma_f32_32x32x16_bf16 v[112:127], a[236:239], a[84:87], v[112:127]
    ds_write_b128 v9, a[160:163] offset:0
    s_waitcnt lgkmcnt(8)
    v_mfma_f32_32x32x16_bf16 v[64:79], a[240:243], a[72:75], v[64:79]
    ds_read_b64_tr_b16 a[232:233], v60 offset:2048
    ds_read_b64_tr_b16 a[234:235], v60 offset:2560
    buffer_load_dwordx4 a[160:163], v13, s[52:55], s89 offen offset:0 sc1
    s_waitcnt lgkmcnt(8)
    v_mfma_f32_32x32x16_bf16 v[80:95], a[244:247], a[72:75], v[80:95]
    ds_read_b64_tr_b16 a[236:237], v33 offset:2048
    ds_read_b64_tr_b16 a[238:239], v33 offset:2560
    v_add_u32 v4, s72, v13
    v_add_u32 v5, 79104, v13
    s_waitcnt vmcnt(21)
    v_mfma_f32_32x32x16_bf16 v[96:111], a[240:243], a[88:91], v[96:111]
    buffer_load_dwordx4 a[216:219], v27, s[52:55], s89 offen offset:0 sc1
    v_mfma_f32_32x32x16_bf16 v[112:127], a[244:247], a[88:91], v[112:127]
    ds_write_b128 v9, a[164:167] offset:1024
    s_waitcnt lgkmcnt(8)
    v_mfma_f32_32x32x16_bf16 v[64:79], a[224:227], a[76:79], v[64:79]
    ds_read_b64_tr_b16 a[240:241], v60 offset:18432
    ds_read_b64_tr_b16 a[242:243], v60 offset:18944
    buffer_load_dwordx4 a[164:167], v13, s[52:55], s89 offen offset:1024 sc1
    s_waitcnt lgkmcnt(8)
    v_mfma_f32_32x32x16_bf16 v[80:95], a[228:231], a[76:79], v[80:95]
    ds_read_b64_tr_b16 a[244:245], v33 offset:18432
    ds_read_b64_tr_b16 a[246:247], v33 offset:18944
    s_xor_b32 s90, s70, 3
    s_mul_i32 s90, s90, 20480
    v_add_u32 v7, s90, v5
    s_waitcnt vmcnt(22)
    v_mfma_f32_32x32x16_bf16 v[96:111], a[224:227], a[92:95], v[96:111]
    buffer_load_dwordx4 a[220:223], v27, s[52:55], s89 offen offset:1024 sc1
    v_mfma_f32_32x32x16_bf16 v[112:127], a[228:231], a[92:95], v[112:127]
    ds_write_b128 v9, a[168:171] offset:2048
    s_waitcnt vmcnt(22) lgkmcnt(8)
    v_mfma_f32_32x32x16_bf16 v[64:79], a[232:235], a[96:99], v[64:79]
    ds_read_b64_tr_b16 a[224:225], v60 offset:4096
    ds_read_b64_tr_b16 a[226:227], v60 offset:4608
    buffer_load_dwordx4 a[248:251], v27, s[52:55], s89 offen offset:2048 sc1
    s_waitcnt lgkmcnt(8)
    v_mfma_f32_32x32x16_bf16 v[80:95], a[236:239], a[96:99], v[80:95]
    ds_read_b64_tr_b16 a[228:229], v33 offset:4096
    ds_read_b64_tr_b16 a[230:231], v33 offset:4608
    s_xor_b32 s90, s70, 2
    s_mul_i32 s90, s90, 20480
    v_add_u32 v6, s90, v5
    s_waitcnt vmcnt(19)
    v_mfma_f32_32x32x16_bf16 v[96:111], a[232:235], a[112:115], v[96:111]
    buffer_load_dwordx4 a[252:255], v27, s[52:55], s89 offen offset:3072 sc1
    v_mfma_f32_32x32x16_bf16 v[112:127], a[236:239], a[112:115], v[112:127]
    ds_write_b128 v9, a[172:175] offset:3072
    s_waitcnt lgkmcnt(8)
    v_mfma_f32_32x32x16_bf16 v[64:79], a[240:243], a[100:103], v[64:79]
    ds_read_b64_tr_b16 a[232:233], v60 offset:6144
    ds_read_b64_tr_b16 a[234:235], v60 offset:6656
    s_waitcnt lgkmcnt(8)
    v_mfma_f32_32x32x16_bf16 v[80:95], a[244:247], a[100:103], v[80:95]
    ds_read_b64_tr_b16 a[236:237], v33 offset:6144
    ds_read_b64_tr_b16 a[238:239], v33 offset:6656
    s_xor_b32 s90, s70, 1
    s_mul_i32 s90, s90, 20480
    v_add_u32 v5, s90, v5
    s_add_u32 s90, s75, 65536
    s_waitcnt vmcnt(19)
    v_mfma_f32_32x32x16_bf16 v[96:111], a[240:243], a[116:119], v[96:111]
    v_mfma_f32_32x32x16_bf16 v[112:127], a[244:247], a[116:119], v[112:127]
    ds_write_b128 v9, a[176:179] offset:4096
    s_waitcnt lgkmcnt(8)
    v_mfma_f32_32x32x16_bf16 v[64:79], a[224:227], a[104:107], v[64:79]
    ds_read_b64_tr_b16 a[240:241], v60 offset:8192
    ds_read_b64_tr_b16 a[242:243], v60 offset:8704
    s_waitcnt lgkmcnt(8)
    v_mfma_f32_32x32x16_bf16 v[80:95], a[228:231], a[104:107], v[80:95]
    ds_read_b64_tr_b16 a[244:245], v33 offset:8192
    ds_read_b64_tr_b16 a[246:247], v33 offset:8704
    s_waitcnt vmcnt(18)
    v_mfma_f32_32x32x16_bf16 v[96:111], a[224:227], a[120:123], v[96:111]
    global_load_dwordx4 v[128:131], v19, s[30:31] offset:0
    global_load_dwordx4 v[132:135], v19, s[30:31] offset:16
    v_mfma_f32_32x32x16_bf16 v[112:127], a[228:231], a[120:123], v[112:127]
    ds_write_b128 v9, a[180:183] offset:5120
    global_load_dwordx4 v[136:139], v19, s[20:21] offset:0
    global_load_dwordx4 v[140:143], v19, s[20:21] offset:16
    s_waitcnt lgkmcnt(8)
    s_nop 0
    v_mfma_f32_32x32x16_bf16 v[64:79], a[232:235], a[108:111], v[64:79]
    ds_read_b64_tr_b16 a[224:225], v60 offset:10240
    ds_read_b64_tr_b16 a[226:227], v60 offset:10752
    v_accvgpr_read_b32 v44, a192
    v_accvgpr_read_b32 v45, a193
    v_accvgpr_read_b32 v46, a194
    v_accvgpr_read_b32 v47, a195
    s_waitcnt lgkmcnt(8)
    v_mfma_f32_32x32x16_bf16 v[80:95], a[236:239], a[108:111], v[80:95]
    ds_read_b64_tr_b16 a[228:229], v33 offset:10240
    ds_read_b64_tr_b16 a[230:231], v33 offset:10752
    s_waitcnt vmcnt(21)
    v_mfma_f32_32x32x16_bf16 v[96:111], a[232:235], a[124:127], v[96:111]
    v_mfma_f32_32x32x16_bf16 v[112:127], a[236:239], a[124:127], v[112:127]
    ds_write_b128 v9, a[184:187] offset:6144
    v_accvgpr_read_b32 v48, a196
    v_accvgpr_read_b32 v49, a197
    v_accvgpr_read_b32 v50, a198
    v_accvgpr_read_b32 v51, a199
    s_waitcnt vmcnt(20) lgkmcnt(8)
    s_nop 0
    v_mfma_f32_32x32x16_bf16 v[64:79], a[240:243], a[128:131], v[64:79]
    ds_read_b64_tr_b16 a[232:233], v60 offset:12288
    ds_read_b64_tr_b16 a[234:235], v60 offset:12800
    v_accvgpr_read_b32 v52, a200
    v_accvgpr_read_b32 v53, a201
    v_accvgpr_read_b32 v54, a202
    v_accvgpr_read_b32 v55, a203
    s_waitcnt lgkmcnt(8)
    v_mfma_f32_32x32x16_bf16 v[80:95], a[244:247], a[128:131], v[80:95]
    ds_read_b64_tr_b16 a[236:237], v33 offset:12288
    ds_read_b64_tr_b16 a[238:239], v33 offset:12800
    s_waitcnt vmcnt(15)
    v_mfma_f32_32x32x16_bf16 v[96:111], a[240:243], a[144:147], v[96:111]
    v_mfma_f32_32x32x16_bf16 v[112:127], a[244:247], a[144:147], v[112:127]
    ds_write_b128 v9, a[188:191] offset:7168
    v_accvgpr_read_b32 v56, a204
    v_accvgpr_read_b32 v57, a205
    v_accvgpr_read_b32 v58, a206
    v_accvgpr_read_b32 v59, a207
    s_waitcnt lgkmcnt(8)
    v_mfma_f32_32x32x16_bf16 v[64:79], a[224:227], a[132:135], v[64:79]
    ds_read_b64_tr_b16 a[240:241], v60 offset:14336
    ds_read_b64_tr_b16 a[242:243], v60 offset:14848
    s_waitcnt lgkmcnt(8)
    v_mfma_f32_32x32x16_bf16 v[80:95], a[228:231], a[132:135], v[80:95]
    ds_read_b64_tr_b16 a[244:245], v33 offset:14336
    ds_read_b64_tr_b16 a[246:247], v33 offset:14848
    v_lshlrev_b32_e64 v152, 16, v44
    v_and_b32_e64 v153, s3, v44
    v_lshlrev_b32_e64 v154, 16, v45
    v_and_b32 v155, s3, v45
    s_waitcnt vmcnt(14)
    v_mfma_f32_32x32x16_bf16 v[96:111], a[224:227], a[148:151], v[96:111]
    v_lshlrev_b32_e64 v156, 16, v46
    v_and_b32_e64 v157, s3, v46
    v_lshlrev_b32_e64 v158, 16, v47
    v_and_b32_e64 v159, s3, v47
    v_mfma_f32_32x32x16_bf16 v[112:127], a[228:231], a[148:151], v[112:127]
    v_lshlrev_b32_e64 v160, 16, v48
    v_and_b32_e64 v161, s3, v48
    v_lshlrev_b32_e64 v162, 16, v49
    v_and_b32 v163, s3, v49
    s_waitcnt lgkmcnt(7)
    v_mfma_f32_32x32x16_bf16 v[64:79], a[232:235], a[136:139], v[64:79]
    ds_read_b64_tr_b16 v[184:185], v32 offset:0
    ds_read_b64_tr_b16 v[186:187], v32 offset:512
    ds_read_b64_tr_b16 v[168:169], v31 offset:0
    ds_read_b64_tr_b16 v[170:171], v31 offset:512
    s_waitcnt lgkmcnt(9)
    s_nop 0
    v_mfma_f32_32x32x16_bf16 v[80:95], a[236:239], a[136:139], v[80:95]
    ds_read_b64_tr_b16 v[188:189], v32 offset:2048
    ds_read_b64_tr_b16 v[190:191], v32 offset:2560
    ds_read_b64_tr_b16 v[172:173], v31 offset:2048
    ds_read_b64_tr_b16 v[174:175], v31 offset:2560
    v_lshlrev_b32_e64 v164, 16, v50
    v_and_b32_e64 v165, s3, v50
    v_lshlrev_b32_e64 v166, 16, v51
    v_and_b32 v167, s3, v51
    s_waitcnt vmcnt(13)
    v_mfma_f32_32x32x16_bf16 v[96:111], a[232:235], a[152:155], v[96:111]
    buffer_load_dword v14, v15, s[52:55], 0 offen sc1
    v_lshlrev_b32_e64 v208, 16, v52
    v_and_b32_e64 v209, s3, v52
    v_lshlrev_b32_e64 v210, 16, v53
    v_and_b32_e64 v211, s3, v53
    v_mfma_f32_32x32x16_bf16 v[112:127], a[236:239], a[152:155], v[112:127]
    v_lshlrev_b32_e64 v212, 16, v54
    v_and_b32_e64 v213, s3, v54
    v_lshlrev_b32_e64 v214, 16, v55
    v_and_b32 v215, s3, v55
    s_waitcnt lgkmcnt(10)
    v_mfma_f32_32x32x16_bf16 v[64:79], a[240:243], a[140:143], v[64:79]
    ds_read_b64_tr_b16 v[192:193], v32 offset:4096
    ds_read_b64_tr_b16 v[194:195], v32 offset:4608
    ds_read_b64_tr_b16 v[176:177], v31 offset:4096
    ds_read_b64_tr_b16 v[178:179], v31 offset:4608
    s_waitcnt lgkmcnt(12)
    s_nop 0
    v_mfma_f32_32x32x16_bf16 v[80:95], a[244:247], a[140:143], v[80:95]
    ds_read_b64_tr_b16 v[196:197], v32 offset:6144
    ds_read_b64_tr_b16 v[198:199], v32 offset:6656
    ds_read_b64_tr_b16 v[180:181], v31 offset:6144
    ds_read_b64_tr_b16 v[182:183], v31 offset:6656
    v_lshlrev_b32_e64 v216, 16, v56
    v_and_b32_e64 v217, s3, v56
    v_lshlrev_b32_e64 v218, 16, v57
    v_and_b32 v219, s3, v57
    s_waitcnt vmcnt(12)
    v_mfma_f32_32x32x16_bf16 v[96:111], a[240:243], a[156:159], v[96:111]
    v_lshlrev_b32_e64 v220, 16, v58
    v_and_b32_e64 v221, s3, v58
    v_lshlrev_b32_e64 v222, 16, v59
    v_and_b32_e64 v223, s3, v59
    v_mfma_f32_32x32x16_bf16 v[112:127], a[244:247], a[156:159], v[112:127]
    s_waitcnt vmcnt(9) lgkmcnt(14)
    v_mfma_f32_32x32x16_bf16 v[112:127], v[184:187], a[216:219], v[112:127]
    s_waitcnt vmcnt(2)
    v_lshlrev_b32_e64 v28, 16, v136
    v_and_b32_e64 v29, s3, v136
    v_lshlrev_b32_e64 v30, 16, v137
    v_and_b32 v31, s3, v137
    s_waitcnt lgkmcnt(10)
    v_mfma_f32_32x32x16_bf16 v[112:127], v[188:191], a[220:223], v[112:127]
    v_lshlrev_b32_e64 v32, 16, v138
    v_and_b32_e64 v33, s3, v138
    v_lshlrev_b32_e64 v34, 16, v139
    v_and_b32 v35, s3, v139
    s_waitcnt lgkmcnt(6)
    v_mfma_f32_32x32x16_bf16 v[112:127], v[192:195], a[248:251], v[112:127]
    s_waitcnt vmcnt(1)
    v_lshlrev_b32 v36, 16, v140
    v_and_b32_e64 v37, s3, v140
    v_lshlrev_b32_e64 v38, 16, v141
    v_and_b32 v39, s3, v141
    s_waitcnt lgkmcnt(2)
    v_mfma_f32_32x32x16_bf16 v[112:127], v[196:199], a[252:255], v[112:127]
    v_lshlrev_b32_e64 v40, 16, v142
    v_and_b32_e64 v41, s3, v142
    v_lshlrev_b32_e64 v42, 16, v143
    v_and_b32_e64 v43, s3, v143
    v_mfma_f32_32x32x16_bf16 v[96:111], v[168:171], a[216:219], v[96:111]
    v_mul_f32_e64 v208, v208, v28
    v_mul_f32_e64 v209, v209, v29
    v_mul_f32_e64 v210, v210, v30
    v_mul_f32_e64 v211, v211, v31
    v_mul_f32 v212, v212, v32
    v_mfma_f32_32x32x16_bf16 v[96:111], v[172:175], a[220:223], v[96:111]
    s_nop 0
    ds_write_b128 v4, v[112:115] offset:8192
    v_mul_f32_e64 v213, v213, v33
    v_mul_f32_e64 v214, v214, v34
    v_mul_f32_e64 v215, v215, v35
    v_mfma_f32_32x32x16_bf16 v[96:111], v[176:179], a[248:251], v[96:111]
    ds_write_b128 v4, v[116:119] offset:9216
    v_mul_f32_e64 v216, v216, v36
    v_mul_f32_e64 v217, v217, v37
    v_mul_f32 v218, v218, v38
    s_waitcnt lgkmcnt(2)
    v_mfma_f32_32x32x16_bf16 v[96:111], v[180:183], a[252:255], v[96:111]
    ds_write_b128 v4, v[120:123] offset:10240
    ds_write_b128 v4, v[124:127] offset:11264
    v_mfma_f32_32x32x16_bf16 v[80:95], v[184:187], a[160:163], v[80:95]
    v_mul_f32_e64 v219, v219, v39
    v_mul_f32_e64 v220, v220, v40
    v_mul_f32_e64 v221, v221, v41
    v_mul_f32_e64 v222, v222, v42
    v_mul_f32 v223, v223, v43
    v_mfma_f32_32x32x16_bf16 v[80:95], v[188:191], a[164:167], v[80:95]
    s_nop 2
    ds_write_b128 v4, v[96:99] offset:4096
    v_lshlrev_b32_e64 v28, 16, v128
    v_and_b32_e64 v29, s3, v128
    v_lshlrev_b32_e64 v30, 16, v129
    v_mfma_f32_32x32x16_bf16 v[80:95], v[192:195], a[208:211], v[80:95]
    ds_write_b128 v4, v[100:103] offset:5120
    v_and_b32_e64 v31, s3, v129
    v_lshlrev_b32_e64 v32, 16, v130
    v_and_b32_e64 v33, s3, v130
    v_mfma_f32_32x32x16_bf16 v[80:95], v[196:199], a[212:215], v[80:95]
    ds_write_b128 v4, v[104:107] offset:6144
    ds_write_b128 v4, v[108:111] offset:7168
    v_mfma_f32_32x32x16_bf16 v[64:79], v[168:171], a[160:163], v[64:79]
    v_lshlrev_b32_e64 v34, 16, v131
    v_and_b32_e64 v35, s3, v131
    v_lshlrev_b32_e64 v36, 16, v132
    v_and_b32_e64 v37, s3, v132
    v_lshlrev_b32 v38, 16, v133
    v_mfma_f32_32x32x16_bf16 v[64:79], v[172:175], a[164:167], v[64:79]
    s_nop 2
    ds_write_b128 v4, v[80:83] offset:0
    v_and_b32_e64 v39, s3, v133
    v_lshlrev_b32_e64 v40, 16, v134
    v_and_b32_e64 v41, s3, v134
    v_mfma_f32_32x32x16_bf16 v[64:79], v[176:179], a[208:211], v[64:79]
    ds_write_b128 v4, v[84:87] offset:1024
    s_waitcnt vmcnt(0)
    v_cmp_ne_u32 vcc, s71, v14
    s_nop 0
    s_and_b64 vcc, vcc, exec
    s_nop 6
    s_cbranch_scc0 P4_ok
    s_mov_b32 s99, 0x40000
P4_lp:
    buffer_load_dword v14, v15, s[52:55], 0 offen sc1
    s_waitcnt vmcnt(0)
    s_sub_u32 s99, s99, 1
    s_cbranch_scc1 P4_ok
    v_cmp_ne_u32_e64 vcc, s71, v14
    s_nop 0
    s_and_b64 vcc, vcc, exec
    s_cbranch_scc1 P4_lp
P4_ok:
    buffer_load_dwordx4 v[144:147], v20, s[52:55], s75 offen sc1
    buffer_load_dwordx4 v[148:151], v20, s[52:55], s90 offen sc1
    v_mfma_f32_32x32x16_bf16 v[64:79], v[180:183], a[212:215], v[64:79]
    ds_write_b128 v4, v[88:91] offset:2048
    ds_write_b128 v4, v[92:95] offset:3072
    v_lshlrev_b32_e64 v42, 16, v135
    v_and_b32_e64 v43, s3, v135
    s_waitcnt lgkmcnt(0)
    s_barrier
    ds_read_b128 v[80:83], v5 offset:0
    ds_read_b128 v[84:87], v5 offset:1024
    ds_read_b128 v[96:99], v6 offset:4096
    ds_read_b128 v[100:103], v6 offset:5120
    ds_read_b128 v[112:115], v7 offset:8192
    ds_read_b128 v[116:119], v7 offset:9216
    ds_read_b128 v[88:91], v5 offset:2048
    ds_read_b128 v[92:95], v5 offset:3072
    ds_read_b128 v[104:107], v6 offset:6144
    ds_read_b128 v[108:111], v6 offset:7168
    ds_read_b128 v[120:123], v7 offset:10240
    ds_read_b128 v[124:127], v7 offset:11264
    s_mov_b32 s90, 0xbfb8aa3b
    v_pk_add_f32 v[64:65], v[64:65], v[28:29]
    v_pk_add_f32 v[66:67], v[66:67], v[30:31]
    v_pk_add_f32 v[68:69], v[68:69], v[32:33]
    v_pk_add_f32 v[70:71], v[70:71], v[34:35]
    v_pk_add_f32 v[72:73], v[72:73], v[36:37]
    v_pk_add_f32 v[74:75], v[74:75], v[38:39]
    v_pk_add_f32 v[76:77], v[76:77], v[40:41]
    v_pk_add_f32 v[78:79], v[78:79], v[42:43]
    s_waitcnt lgkmcnt(11)
    v_pk_add_f32 v[64:65], v[64:65], v[80:81]
    v_pk_add_f32 v[66:67], v[66:67], v[82:83]
    s_waitcnt lgkmcnt(10)
    v_pk_add_f32 v[68:69], v[68:69], v[84:85]
    v_pk_add_f32 v[70:71], v[70:71], v[86:87]
    s_waitcnt lgkmcnt(9)
    v_pk_add_f32 v[64:65], v[64:65], v[96:97]
    v_pk_add_f32 v[66:67], v[66:67], v[98:99]
    s_waitcnt lgkmcnt(8)
    v_pk_add_f32 v[68:69], v[68:69], v[100:101]
    v_pk_add_f32 v[70:71], v[70:71], v[102:103]
    s_waitcnt lgkmcnt(7)
    v_pk_add_f32 v[64:65], v[64:65], v[112:113]
    v_pk_add_f32 v[66:67], v[66:67], v[114:115]
    s_waitcnt lgkmcnt(6)
    v_pk_add_f32 v[68:69], v[68:69], v[116:117]
    v_pk_add_f32 v[70:71], v[70:71], v[118:119]
    v_pk_mul_f32 v[28:29], v[64:65], s[90:91] op_sel_hi:[1,0]
    v_pk_mul_f32 v[30:31], v[66:67], s[90:91] op_sel_hi:[1,0]
    v_pk_mul_f32 v[32:33], v[68:69], s[90:91] op_sel_hi:[1,0]
    v_pk_mul_f32 v[34:35], v[70:71], s[90:91] op_sel_hi:[1,0]
    v_exp_f32_e64 v28, v28
    v_exp_f32_e64 v29, v29
    v_exp_f32_e64 v30, v30
    v_exp_f32_e64 v31, v31
    v_exp_f32_e64 v32, v32
    v_exp_f32_e64 v33, v33
    v_exp_f32_e64 v34, v34
    v_exp_f32_e64 v35, v35
    v_pk_add_f32 v[28:29], v[28:29], 1.0 op_sel_hi:[1,0]
    v_pk_add_f32 v[30:31], v[30:31], 1.0 op_sel_hi:[1,0]
    v_pk_add_f32 v[32:33], v[32:33], 1.0 op_sel_hi:[1,0]
    v_pk_add_f32 v[34:35], v[34:35], 1.0 op_sel_hi:[1,0]
    v_rcp_f32_e64 v28, v28
    v_rcp_f32_e64 v29, v29
    v_rcp_f32_e64 v30, v30
    v_rcp_f32_e64 v31, v31
    v_rcp_f32_e64 v32, v32
    v_rcp_f32_e64 v33, v33
    v_rcp_f32_e64 v34, v34
    v_rcp_f32_e64 v35, v35
    v_pk_mul_f32 v[28:29], v[28:29], v[64:65]
    v_pk_mul_f32 v[30:31], v[30:31], v[66:67]
    v_pk_mul_f32 v[32:33], v[32:33], v[68:69]
    v_pk_mul_f32 v[34:35], v[34:35], v[70:71]
    s_waitcnt lgkmcnt(5)
    v_pk_add_f32 v[72:73], v[72:73], v[88:89]
    v_pk_add_f32 v[74:75], v[74:75], v[90:91]
    s_waitcnt lgkmcnt(4)
    v_pk_add_f32 v[76:77], v[76:77], v[92:93]
    v_pk_add_f32 v[78:79], v[78:79], v[94:95]
    s_waitcnt lgkmcnt(3)
    v_pk_add_f32 v[72:73], v[72:73], v[104:105]
    v_pk_add_f32 v[74:75], v[74:75], v[106:107]
    s_waitcnt lgkmcnt(2)
    v_pk_add_f32 v[76:77], v[76:77], v[108:109]
    v_pk_add_f32 v[78:79], v[78:79], v[110:111]
    s_waitcnt lgkmcnt(1)
    v_pk_add_f32 v[72:73], v[72:73], v[120:121]
    v_pk_add_f32 v[74:75], v[74:75], v[122:123]
    s_waitcnt lgkmcnt(0)
    v_pk_add_f32 v[76:77], v[76:77], v[124:125]
    v_pk_add_f32 v[78:79], v[78:79], v[126:127]
    s_waitcnt vmcnt(1)
    ds_write_b128 v21, v[144:147]
    s_waitcnt vmcnt(0)
    ds_write_b128 v21, v[148:151] offset:1024
    ds_read_b64_tr_b16 v[144:145], v22 offset:0
    ds_read_b64_tr_b16 v[146:147], v22 offset:256
    ds_read_b64_tr_b16 v[148:149], v22 offset:512
    ds_read_b64_tr_b16 v[150:151], v22 offset:768
    v_pk_mul_f32 v[36:37], v[72:73], s[90:91] op_sel_hi:[1,0]
    v_pk_mul_f32 v[38:39], v[74:75], s[90:91] op_sel_hi:[1,0]
    v_pk_mul_f32 v[40:41], v[76:77], s[90:91] op_sel_hi:[1,0]
    v_pk_mul_f32 v[42:43], v[78:79], s[90:91] op_sel_hi:[1,0]
    v_exp_f32_e64 v36, v36
    v_exp_f32_e64 v37, v37
    v_exp_f32_e64 v38, v38
    v_exp_f32_e64 v39, v39
    v_exp_f32_e64 v40, v40
    v_exp_f32_e64 v41, v41
    v_exp_f32_e64 v42, v42
    v_exp_f32_e64 v43, v43
    v_pk_add_f32 v[36:37], v[36:37], 1.0 op_sel_hi:[1,0]
    v_pk_add_f32 v[38:39], v[38:39], 1.0 op_sel_hi:[1,0]
    v_pk_add_f32 v[40:41], v[40:41], 1.0 op_sel_hi:[1,0]
    v_pk_add_f32 v[42:43], v[42:43], 1.0 op_sel_hi:[1,0]
    v_rcp_f32_e64 v36, v36
    v_rcp_f32_e64 v37, v37
    v_rcp_f32_e64 v38, v38
    v_rcp_f32_e64 v39, v39
    v_rcp_f32_e64 v40, v40
    v_rcp_f32_e64 v41, v41
    v_rcp_f32_e64 v42, v42
    v_rcp_f32_e64 v43, v43
    v_pk_mul_f32 v[36:37], v[36:37], v[72:73]
    v_pk_mul_f32 v[38:39], v[38:39], v[74:75]
    v_pk_mul_f32 v[40:41], v[40:41], v[76:77]
    v_pk_mul_f32 v[42:43], v[42:43], v[78:79]
    s_waitcnt lgkmcnt(3)
    v_lshlrev_b32 v44, 16, v144
    v_and_b32_e64 v45, s3, v144
    v_lshlrev_b32_e64 v46, 16, v145
    v_and_b32 v47, s3, v145
    s_waitcnt lgkmcnt(2)
    v_lshlrev_b32_e64 v48, 16, v146
    v_and_b32_e64 v49, s3, v146
    v_lshlrev_b32_e64 v50, 16, v147
    v_and_b32_e64 v51, s3, v147
    v_pk_add_f32 v[208:209], v[208:209], v[44:45]
    v_pk_add_f32 v[210:211], v[210:211], v[46:47]
    v_pk_add_f32 v[212:213], v[212:213], v[48:49]
    v_pk_add_f32 v[214:215], v[214:215], v[50:51]
    v_pk_fma_f32 v[208:209], v[208:209], v[28:29], v[152:153]
    v_pk_fma_f32 v[210:211], v[210:211], v[30:31], v[154:155]
    v_pk_fma_f32 v[212:213], v[212:213], v[32:33], v[156:157]
    v_pk_fma_f32 v[214:215], v[214:215], v[34:35], v[158:159]
    v_cvt_pk_bf16_f32 v144, v208, v209
    v_cvt_pk_bf16_f32 v145, v210, v211
    v_cvt_pk_bf16_f32 v146, v212, v213
    v_cvt_pk_bf16_f32 v147, v214, v215
    buffer_store_dwordx4 v[144:147], v16, s[56:59], s92 offen offset:0
    s_waitcnt lgkmcnt(1)
    v_lshlrev_b32 v52, 16, v148
    v_and_b32_e64 v53, s3, v148
    v_lshlrev_b32_e64 v54, 16, v149
    v_and_b32 v55, s3, v149
    s_waitcnt lgkmcnt(0)
    v_lshlrev_b32_e64 v56, 16, v150
    v_and_b32_e64 v57, s3, v150
    v_lshlrev_b32_e64 v58, 16, v151
    v_and_b32_e64 v59, s3, v151
    v_pk_add_f32 v[216:217], v[216:217], v[52:53]
    v_pk_add_f32 v[218:219], v[218:219], v[54:55]
    v_pk_add_f32 v[220:221], v[220:221], v[56:57]
    v_pk_add_f32 v[222:223], v[222:223], v[58:59]
    v_pk_fma_f32 v[216:217], v[216:217], v[36:37], v[160:161]
    v_pk_fma_f32 v[218:219], v[218:219], v[38:39], v[162:163]
    v_pk_fma_f32 v[220:221], v[220:221], v[40:41], v[164:165]
    v_pk_fma_f32 v[222:223], v[222:223], v[42:43], v[166:167]
    v_cvt_pk_bf16_f32 v148, v216, v217
    v_cvt_pk_bf16_f32 v149, v218, v219
    v_cvt_pk_bf16_f32 v150, v220, v221
    v_cvt_pk_bf16_f32 v151, v222, v223
    buffer_store_dwordx4 v[148:151], v16, s[56:59], s92 offen offset:16
    s_waitcnt vmcnt(0)
    s_endpgm
END:
    s_endpgm
END0:
    s_waitcnt lgkmcnt(0)
    s_endpgm
.section .rodata,"a"
.p2align 6
.amdhsa_kernel recurrent_scan__ssm_conv_s4__mixer_channel_mlp__prompt_kernel
  .amdhsa_next_free_vgpr 512
  .amdhsa_next_free_sgpr 102
  .amdhsa_accum_offset 256
  .amdhsa_group_segment_fixed_size 0
  .amdhsa_kernarg_size 136
  .amdhsa_user_sgpr_count 2
  .amdhsa_user_sgpr_kernarg_segment_ptr 1
  .amdhsa_system_sgpr_workgroup_id_x 1
.end_amdhsa_kernel
```
